```python
import torch

def _softmax(x, axis=-1):
    return torch.softmax(x, dim=axis)
def _gelu(x):
    return torch.nn.functional.gelu(x, approximate="tanh")
def _silu(x):
    return torch.nn.functional.silu(x)
def _sigmoid(x):
    return torch.sigmoid(x)
def _layernorm(x, axis=-1, eps=1e-5):
    m = x.mean(dim=axis, keepdim=True)
    v = x.var(dim=axis, keepdim=True, unbiased=False)
    return (x - m) / torch.sqrt(v + eps)
def _scatter_add(tgt, idx, src, axis=0):
    return tgt.clone().index_add_(axis, idx, src)
def _segment_sum(src, seg, n):
    out = torch.zeros((n,) + src.shape[1:], dtype=src.dtype)
    return out.index_add_(0, seg, src)
def _pad(x, pw):
    flat = tuple(v for pair in reversed(pw) for v in pair)
    return torch.nn.functional.pad(x, flat)

kernel_name = 'sequential_preLN__spectral_fnet__swiglu_ffn__prompt'

def setup_inputs():

    _w = (lambda a: (lambda t: t.to(torch.bfloat16) if t.is_floating_point() else t)(torch.as_tensor(a)))
    def _A_setup():
        B, S, D = 1, 2048, 512
        ns = torch.arange(S)[:, None] * torch.arange(S)[None, :]
        nd = torch.arange(D)[:, None] * torch.arange(D)[None, :]
        Ws_re = torch.cos(-2.0 * torch.pi * ns / S).to(float)
        Ws_im = torch.sin(-2.0 * torch.pi * ns / S).to(float)
        Wd_re = torch.cos(-2.0 * torch.pi * nd / D).to(float)
        Wd_im = torch.sin(-2.0 * torch.pi * nd / D).to(float)
        return {
            "x": _w((lambda *s: torch.randn(*s, dtype=torch.bfloat16) * 0.05)(B, S, D)),
            "dft_seq_re": _w(Ws_re),
            "dft_seq_im": _w(Ws_im),
            "dft_hid_re": _w(Wd_re),
            "dft_hid_im": _w(Wd_im),
        }
    _A_in = _A_setup()

    def _B_setup():
        B, S, D, F = 1, 2048, 512, 1792
        return {
            "x": _w((lambda *s: torch.randn(*s, dtype=torch.bfloat16) * 0.05)(B, S, D)),
            "w_gate": _w((lambda *s: torch.randn(*s, dtype=torch.bfloat16) * 0.2)(D, F)),
            "w_up": _w((lambda *s: torch.randn(*s, dtype=torch.bfloat16) * 0.2)(D, F)),
            "w_down": _w((lambda *s: torch.randn(*s, dtype=torch.bfloat16) * 0.2)(F, D)),
        }
    _B_in = _B_setup()

    return {
        "A_x": _A_in["x"],
        "A_dft_seq_re": _A_in["dft_seq_re"],
        "A_dft_seq_im": _A_in["dft_seq_im"],
        "A_dft_hid_re": _A_in["dft_hid_re"],
        "A_dft_hid_im": _A_in["dft_hid_im"],
        "B_x": _B_in["x"],
        "B_w_gate": _B_in["w_gate"],
        "B_w_up": _B_in["w_up"],
        "B_w_down": _B_in["w_down"],
    }

def reference(A_x, A_dft_seq_re, A_dft_seq_im, A_dft_hid_re, A_dft_hid_im, B_x, B_w_gate, B_w_up, B_w_down):
    def _A_ref(x, dft_seq_re, dft_seq_im, dft_hid_re, dft_hid_im):
        a = torch.einsum("bsd,ed->bse", x, dft_hid_re)
        b = torch.einsum("bsd,ed->bse", x, dft_hid_im)
        y = torch.einsum("ts,bse->bte", dft_seq_re, a) - torch.einsum("ts,bse->bte", dft_seq_im, b)
        return y

    def _B_ref(x, w_gate, w_up, w_down):
        g = _silu(x @ w_gate)
        u = x @ w_up
        return (g * u) @ w_down

    x = A_x
    h = x + _A_ref(_layernorm(x, axis=-1), A_dft_seq_re, A_dft_seq_im, A_dft_hid_re, A_dft_hid_im)
    h2 = h + _B_ref(_layernorm(h, axis=-1), B_w_gate, B_w_up, B_w_down)
    return h2
```

```asm
; @launch grid=(256,1,1) block=(512,1,1) lds=163840
.amdgcn_target "amdgcn-amd-amdhsa--gfx950"
.text
.p2align 12
.fill 832, 4, 0xbf800000
.text
.globl sequential_preLN__spectral_fnet__swiglu_ffn__prompt_kernel
.p2align 8
.type sequential_preLN__spectral_fnet__swiglu_ffn__prompt_kernel,@function
sequential_preLN__spectral_fnet__swiglu_ffn__prompt_kernel:
    s_load_dwordx2 s[12:13], s[0:1], 0
    s_load_dwordx2 s[6:7], s[0:1], 88
    s_load_dwordx8 s[40:47], s[0:1], 48
    s_cmp_ge_u32 s2, 256
    s_cbranch_scc1 L_end
    v_lshrrev_b32 v2, 6, v0
    s_getpc_b64 s[52:53]
    v_lshlrev_b32 v4, 7, v0
    v_min_u32 v4, L_g2 - sequential_preLN__spectral_fnet__swiglu_ffn__prompt_kernel, v4
    v_add_co_u32 v4, vcc, s52, v4
    v_mov_b32 v5, s53
    v_and_b32 v0, 63, v0
    v_addc_co_u32 v5, vcc, 0, v5, vcc
    global_load_dword v62, v[4:5], off
    v_readfirstlane_b32 s3, v2
    v_lshlrev_b32 v1, 4, v0
    s_and_b32 s28, s2, 4
    s_lshl_b32 s28, s28, 1
    s_bfe_u32 s29, s2, 0x30003
    s_add_u32 s21, s28, s29
    s_bfe_u32 s32, s2, 0x10001
    s_sub_u32 s28, 32, s21
    s_cmp_eq_u32 s21, 0
    s_cselect_b32 s31, 16, s28
    s_cselect_b32 s34, 1, 3
    s_lshr_b32 s28, s3, 2
    s_xor_b32 s28, s28, s32
    s_sub_u32 s29, 4, s34
    s_bitcmp1_b32 s3, 1
    s_cselect_b32 s29, 2, s29
    s_cselect_b32 s30, s34, 0
    s_cmp_eq_u32 s28, 0
    s_cselect_b32 s28, s30, s29
    s_bitcmp1_b32 s28, 1
    s_cselect_b32 s29, s31, s21
    s_and_b32 s30, s28, 1
    s_lshl_b32 s30, s30, 5
    s_add_u32 s29, s29, s30
    s_and_b32 s24, s3, 1
    s_lshl1_add_u32 s28, s28, s24
    s_lshl_b32 s100, s28, 11
    s_lshl_b32 s30, s24, 10
    s_add_u32 s36, s29, s30
    s_lshl_b32 s101, s36, 10
    s_and_b32 s28, s2, 1
    s_lshr_b32 s29, s2, 6
    s_lshl2_add_u32 s33, s28, s29
    s_and_b32 s20, s3, 3
    v_and_b32 v2, 15, v0
    v_lshrrev_b32 v3, 4, v0
    v_lshrrev_b32 v4, 3, v0
    v_and_b32 v5, 7, v0
    v_lshrrev_b32 v6, 1, v4
    v_xor_b32 v6, v5, v6
    v_lshlrev_b32_e64 v6, 4, v6
    v_lshl_add_u32 v6, v4, 16, v6
    v_xor_b32 v7, 0x80040, v6
    s_mov_b32 s14, 0x200000
    s_mov_b32 s15, 0x20000
    s_cmp_ge_u32 s3, 4
    s_cbranch_scc1 L_mover
    s_setprio 1
    v_lshrrev_b32 v18, 1, v2
    v_xor_b32 v18, v3, v18
    v_lshlrev_b32 v18, 4, v18
    v_lshl_add_u32 v18, v2, 7, v18
    s_add_u32 m0, s100, 32768
    v_add_u32_e64 v18, m0, v18
    v_mov_b32 v28, 0x3f803f80
    s_waitcnt lgkmcnt(0)
    s_and_b32 s13, s13, 0xffff
    buffer_load_dwordx4 v6, s[12:15], s101 offen offset:0 lds
    s_addk_i32 m0, 1024
    v_xor_b32_e64 v19, 64, v18
    buffer_load_dwordx4 v7, s[12:15], s101 offen offset:0 lds
    s_addk_i32 m0, 15232
    v_mov_b32 v29, v28
    buffer_load_dwordx4 v6, s[12:15], s101 offen offset:128 lds
    s_addk_i32 m0, 1024
    v_mov_b32 v30, v28
    buffer_load_dwordx4 v7, s[12:15], s101 offen offset:128 lds
    s_addk_i32 m0, 15232
    v_mov_b32 v31, v28
    buffer_load_dwordx4 v6, s[12:15], s101 offen offset:256 lds
    s_addk_i32 m0, 1024
    v_lshlrev_b32 v17, 31, v2
    buffer_load_dwordx4 v7, s[12:15], s101 offen offset:256 lds
    s_addk_i32 m0, 15232
    v_or_b32 v17, 1.0, v17
    buffer_load_dwordx4 v6, s[12:15], s101 offen offset:384 lds
    s_addk_i32 m0, 1024
    v_cvt_f32_u32 v10, v2
    buffer_load_dwordx4 v7, s[12:15], s101 offen offset:384 lds
    s_addk_i32 m0, 15232
    v_and_b32 v12, 1, v0
    s_branch L_main
L_mover:
    s_lshl_b32 s28, s33, 5
    v_lshl_add_u32 v112, v2, 1, s28
    v_mov_b32 v113, 0x100
    v_cmp_eq_u32 vcc, 0, v112
    s_lshl_b32 s28, s20, 5
    s_nop 0
    v_cndmask_b32 v113, v112, v113, vcc
    v_or_b32_e64 v112, 1, v112
    v_lshl_add_u32 v114, v3, 3, s28
    v_cvt_f32_u32 v114, v114
    s_lshl_b32 s28, s20, 12
    v_add_u32 v117, s28, v1
    v_cvt_f32_u32 v113, v113
    v_mul_f32 v113, 0xbb000000, v113
    v_mul_f32 v115, v114, v113
    v_add_f32 v116, v115, v113
    v_cos_f32 v14, v115
    v_sin_f32 v16, v115
    v_cos_f32 v15, v116
    v_sin_f32 v17, v116
    v_add_f32_e64 v115, v116, v113
    v_cvt_pk_bf16_f32 v128, v14, v15
    v_cvt_pk_bf16_f32 v132, v16, v17
    v_add_f32 v116, v115, v113
    v_cos_f32 v14, v115
    v_sin_f32 v16, v115
    v_cos_f32 v15, v116
    v_sin_f32 v17, v116
    v_add_f32 v115, v116, v113
    v_cvt_pk_bf16_f32 v129, v14, v15
    v_cvt_pk_bf16_f32 v133, v16, v17
    v_add_f32 v116, v115, v113
    v_cos_f32 v14, v115
    v_sin_f32 v16, v115
    v_cos_f32 v15, v116
    v_sin_f32 v17, v116
    v_add_f32 v115, v116, v113
    v_cvt_pk_bf16_f32 v130, v14, v15
    v_cvt_pk_bf16_f32 v134, v16, v17
    v_add_f32 v116, v115, v113
    v_cos_f32 v14, v115
    v_sin_f32 v16, v115
    v_cos_f32 v15, v116
    v_sin_f32 v17, v116
    v_add_f32 v115, v116, v113
    v_cvt_pk_bf16_f32 v131, v14, v15
    v_cvt_pk_bf16_f32 v135, v16, v17
    ds_write_b128 v117, v[128:131] offset:0
    ds_write_b128 v117, v[132:135] offset:1024
    v_cvt_f32_u32_e64 v112, v112
    v_mul_f32 v112, 0xbb000000, v112
    v_mul_f32 v115, v114, v112
    v_add_f32 v116, v115, v112
    v_cos_f32 v14, v115
    v_sin_f32 v16, v115
    v_cos_f32 v15, v116
    v_sin_f32 v17, v116
    v_add_f32_e64 v115, v116, v112
    v_cvt_pk_bf16_f32 v136, v14, v15
    v_cvt_pk_bf16_f32 v140, v16, v17
    v_add_f32 v116, v115, v112
    v_cos_f32 v14, v115
    v_sin_f32 v16, v115
    v_cos_f32 v15, v116
    v_sin_f32 v17, v116
    v_add_f32 v115, v116, v112
    v_cvt_pk_bf16_f32 v137, v14, v15
    v_cvt_pk_bf16_f32 v141, v16, v17
    v_add_f32 v116, v115, v112
    v_cos_f32 v14, v115
    v_sin_f32 v16, v115
    v_cos_f32 v15, v116
    v_sin_f32 v17, v116
    v_add_f32 v115, v116, v112
    v_cvt_pk_bf16_f32 v138, v14, v15
    v_cvt_pk_bf16_f32 v142, v16, v17
    v_add_f32 v116, v115, v112
    v_cos_f32 v14, v115
    v_sin_f32 v16, v115
    v_cos_f32 v15, v116
    v_sin_f32 v17, v116
    v_add_f32 v115, v116, v112
    v_cvt_pk_bf16_f32 v139, v14, v15
    v_cvt_pk_bf16_f32 v143, v16, v17
    ds_write_b128 v117, v[136:139] offset:2048
    ds_write_b128 v117, v[140:143] offset:3072
    s_and_b32 s28, s2, 7
    s_lshl2_add_u32 s4, s28, s20
    s_lshr_b32 s28, s4, 1
    s_lshl_b32 s28, s28, 5
    s_sub_u32 s29, 768, s28
    s_cmp_ge_u32 s4, 16
    s_cselect_b32 s28, s29, s28
    s_cselect_b32 s29, -1, 1
    v_mov_b32 v8, s28
    v_mad_i32_i24 v8, v4, s29, v8
    s_mul_i32 s50, s29, 28672
    s_movk_i32 s30, 3584
    v_lshlrev_b32 v18, 4, v5
    v_mad_u32_u24 v9, v8, s30, v18
    v_cmp_eq_u32 vcc, 0x200, v8
    v_subrev_u32 v8, 917504, v9
    s_lshr_b32 s28, s2, 3
    s_lshl_b32 s56, s28, 7
    v_cndmask_b32 v8, v9, v8, vcc
    v_add_u32 v9, s50, v9
    v_add_u32 v10, s50, v9
    v_add_u32 v11, s50, v10
    s_cmp_ge_u32 s2, 224
    s_cselect_b32 s56, 536870912, s56
    s_lshl_b32 s37, s20, 12
    s_add_u32 s37, s37, 16384
    s_sub_u32 s28, 255, s2
    s_lshl1_add_u32 s95, s28, s24
    s_cmp_ge_u32 s95, 384
    s_cselect_b32 s51, 14, 7
    s_cselect_b32 s54, 1, 4
    s_cselect_b32 s55, 8, 4
    s_cselect_b32 s30, 56, 4
    v_and_b32 v20, 1, v3
    v_mul_u32_u24 v20, s55, v20
    v_and_b32_e64 v21, 2, v3
    v_mad_u32_u24 v20, v21, s30, v20
    v_lshlrev_b32_e64 v20, 10, v20
    v_lshl_add_u32 v20, v2, 3, v20
    s_bfe_u32 s50, s95, 0x40003
    s_mul_i32 s50, s50, s51
    s_lshr_b32 s28, s95, 7
    s_lshl1_add_u32 s50, s28, s50
    s_lshl_b32 s50, s50, 7
    s_and_b32 s28, s95, 7
    s_add_u32 s50, s50, s28
    s_lshl_b32 s50, s50, 7
    s_cmp_ge_u32 s95, 448
    s_cselect_b32 s50, 536870912, s50
    s_lshl_b32 s54, s54, 12
    s_add_u32 s51, s50, s54
    s_lshr_b32 s28, s2, 3
    s_lshl2_add_u32 s28, s28, s20
    s_lshl_b32 s28, s28, 8
    s_add_u32 s28, s28, L_g2 - sequential_preLN__spectral_fnet__swiglu_ffn__prompt_kernel
    v_lshl_add_u32 v22, v0, 2, s28
    v_min_u32 v22, L_end - sequential_preLN__spectral_fnet__swiglu_ffn__prompt_kernel - 64, v22
    v_add_co_u32 v22, vcc, s52, v22
    v_mov_b32 v23, s53
    s_nop 0
    v_addc_co_u32 v23, vcc, 0, v23, vcc
    s_mov_b32 s18, 1835008
    s_mov_b32 s19, 0x20000
    s_mov_b32 s10, 0x10000000
    s_mov_b32 s11, 0x20000
    s_mov_b32 s62, 6651776
    s_waitcnt lgkmcnt(0)
    s_bitcmp1_b32 s20, 0
    s_cselect_b32 s16, s42, s40
    s_cselect_b32 s17, s43, s41
    s_and_b32 s17, s17, 0xffff
    s_mov_b32 s8, s6
    s_and_b32 s9, s7, 0xffff
    s_mov_b32 m0, s37
    s_barrier
    buffer_load_dword v19, off, s[8:11], s62 sc1
    global_load_dword v24, v[22:23], off
    buffer_load_dwordx4 v8, s[16:19], s56 offen lds
    s_addk_i32 m0, 1024
    s_mov_b64 s[38:39], s[46:47]
    buffer_load_dwordx4 v9, s[16:19], s56 offen lds
    s_addk_i32 m0, 1024
    s_and_b32 s13, s13, 0xffff
    buffer_load_dwordx4 v10, s[16:19], s56 offen lds
    s_addk_i32 m0, 1024
    s_nop 0
    buffer_load_dwordx4 v11, s[16:19], s56 offen lds
    s_mov_b32 s16, s44
    s_and_b32 s17, s45, 0xffff
    s_cmp_lt_u32 s20, 2
    s_cbranch_scc1 L_mover2
    buffer_load_dwordx2 v[96:97], v20, s[16:19], s50 offen offset:0
    buffer_load_dwordx2 v[98:99], v20, s[16:19], s50 offen offset:1024
    buffer_load_dwordx2 v[100:101], v20, s[16:19], s50 offen offset:2048
    buffer_load_dwordx2 v[102:103], v20, s[16:19], s50 offen offset:3072
    buffer_load_dwordx2 v[104:105], v20, s[16:19], s51 offen offset:0
    buffer_load_dwordx2 v[106:107], v20, s[16:19], s51 offen offset:1024
    buffer_load_dwordx2 v[108:109], v20, s[16:19], s51 offen offset:2048
    buffer_load_dwordx2 v[110:111], v20, s[16:19], s51 offen offset:3072
    s_branch L_mover2
L_main:
    buffer_load_dwordx4 v6, s[12:15], s101 offen offset:512 lds
    s_addk_i32 m0, 1024
    v_and_b32 v13, 2, v0
    v_lshrrev_b32 v14, 2, v2
    s_mov_b32 s8, s6
    v_add_u32 v60, 65536, v18
    v_add_u32 v61, 65536, v19
    s_lshl_b32 s28, s32, 5
    s_add_u32 s48, s28, s21
    s_cmp_eq_u32 s48, 0
    s_cselect_b32 s58, 0, 1.0
    s_cselect_b32 s60, 0, 0xbe800000
    buffer_load_dwordx4 v7, s[12:15], s101 offen offset:512 lds
    s_addk_i32 m0, 15232
    s_cmp_eq_u32 s48, 32
    s_cselect_b32 s60, 0xbe000000, s60
    s_cselect_b32 s59, 0xbe000000, 0
    s_cselect_b32 s61, 0x3eb504f3, 0.5
    s_cselect_b32 s48, 48, s48
    s_sub_u32 s28, 4, s34
    s_cmp_eq_u32 s32, 0
    s_cselect_b32 s92, s28, 0
    s_cselect_b32 s93, 2, s34
    s_lshl_b32 s92, s92, 12
    s_lshl_b32 s93, s93, 12
    s_add_u32 s94, s92, 114688
    s_bitcmp1_b32 s3, 1
    s_cselect_b32 s37, s60, s59
    s_cmp_eq_u32 s48, 0
    s_cselect_b32 s56, 0, -1
    buffer_load_dwordx4 v6, s[12:15], s101 offen offset:640 lds
    s_addk_i32 m0, 1024
    v_cmp_eq_u32 s[50:51], 1, v12
    v_cmp_eq_u32 s[52:53], 2, v13
    v_cmp_eq_u32 s[54:55], v14, v3
    v_lshl_add_u32 v8, v3, 8, s36
    v_cvt_f32_u32 v8, v8
    v_add_f32 v11, 0x00000000, v10
    v_mul_f32 v11, 0x3a000000, v11
    v_fma_f32 v12, v11, v8, s37
    buffer_load_dwordx4 v7, s[12:15], s101 offen offset:640 lds
    s_addk_i32 m0, 15232
    v_fmamk_f32 v13, v11, 0x00000000, v12
    v_fmamk_f32 v14, v11, 0x42800000, v12
    v_cos_f32 v15, v13
    v_cos_f32 v16, v14
    v_sin_f32 v13, v13
    v_sin_f32_e64 v14, v14
    v_cvt_pk_f16_f32 v112, v15, v16
    v_cvt_pk_f16_f32 v114, v13, v14
    buffer_load_dwordx4 v6, s[12:15], s101 offen offset:768 lds
    s_addk_i32 m0, 1024
    v_cvt_pk_f16_f32 v120, -v13, -v14
    v_and_b32 v122, s56, v112
    v_and_b32_e64 v120, s56, v120
    v_fmamk_f32 v13, v11, 0x43000000, v12
    v_fmamk_f32 v14, v11, 0x43400000, v12
    v_cos_f32 v15, v13
    v_cos_f32 v16, v14
    v_sin_f32_e64 v13, v13
    buffer_load_dwordx4 v7, s[12:15], s101 offen offset:768 lds
    s_addk_i32 m0, 15232
    v_sin_f32 v14, v14
    v_cvt_pk_f16_f32 v113, v15, v16
    v_cvt_pk_f16_f32 v115, v13, v14
    v_cvt_pk_f16_f32 v121, -v13, -v14
    v_and_b32 v123, s56, v113
    v_and_b32 v121, s56, v121
    v_add_f32 v11, 0x41800000, v10
    v_mul_f32 v11, 0x3a000000, v11
    buffer_load_dwordx4 v6, s[12:15], s101 offen offset:896 lds
    s_addk_i32 m0, 1024
    v_fma_f32 v12, v11, v8, s37
    v_fmamk_f32 v13, v11, 0x00000000, v12
    v_fmamk_f32 v14, v11, 0x42800000, v12
    v_cos_f32 v15, v13
    v_cos_f32 v16, v14
    v_sin_f32 v13, v13
    v_sin_f32_e64 v14, v14
    v_cvt_pk_f16_f32 v116, v15, v16
    buffer_load_dwordx4 v7, s[12:15], s101 offen offset:896 lds
    s_barrier
    ds_read_b128 v[192:195], v1 offset:0
    ds_read_b128 v[196:199], v1 offset:1024
    ds_read_b128 v[200:203], v1 offset:2048
    ds_read_b128 v[204:207], v1 offset:3072
    s_waitcnt vmcnt(14)
    ds_read_b128 v[128:131], v18 offset:0
    ds_read_b128 v[132:135], v19 offset:0
    s_waitcnt lgkmcnt(1)
    v_mfma_f32_16x16x32_bf16 v[20:23], v[128:131], v[128:131], 0
    ds_read_b128 v[208:211], v1 offset:4096
    ds_read_b128 v[212:215], v1 offset:5120
    v_mfma_f32_16x16x32_bf16 v[24:27], v[128:131], v[28:31], 0
    ds_read_b128 v[216:219], v1 offset:6144
    ds_read_b128 v[220:223], v1 offset:7168
    s_waitcnt vmcnt(12)
    ds_read_b128 v[136:139], v18 offset:16384
    ds_read_b128 v[140:143], v19 offset:16384
    s_waitcnt lgkmcnt(6)
    v_mfma_f32_16x16x32_bf16 v[20:23], v[132:135], v[132:135], v[20:23]
    ds_read_b128 v[224:227], v1 offset:8192
    ds_read_b128 v[228:231], v1 offset:9216
    v_mfma_f32_16x16x32_bf16 v[24:27], v[132:135], v[28:31], v[24:27]
    ds_read_b128 v[232:235], v1 offset:10240
    ds_read_b128 v[236:239], v1 offset:11264
    v_mfma_f32_16x16x32_bf16 v[64:67], v[128:131], v[192:195], 0
    v_cvt_pk_f16_f32 v118, v13, v14
    v_mfma_f32_16x16x32_bf16 v[68:71], v[128:131], v[196:199], 0
    v_cvt_pk_f16_f32 v124, -v13, -v14
    v_mfma_f32_16x16x32_bf16 v[80:83], v[128:131], v[200:203], 0
    v_and_b32 v126, s56, v116
    v_mfma_f32_16x16x32_bf16 v[84:87], v[128:131], v[204:207], 0
    v_and_b32 v124, s56, v124
    s_waitcnt lgkmcnt(6)
    v_mfma_f32_16x16x32_bf16 v[64:67], v[132:135], v[208:211], v[64:67]
    v_fmamk_f32 v13, v11, 0x43000000, v12
    v_mfma_f32_16x16x32_bf16 v[68:71], v[132:135], v[212:215], v[68:71]
    v_fmamk_f32 v14, v11, 0x43400000, v12
    v_mfma_f32_16x16x32_bf16 v[80:83], v[132:135], v[216:219], v[80:83]
    v_cos_f32_e64 v15, v13
    v_mfma_f32_16x16x32_bf16 v[84:87], v[132:135], v[220:223], v[84:87]
    v_cos_f32 v16, v14
    s_waitcnt vmcnt(10)
    ds_read_b128 v[144:147], v18 offset:32768
    ds_read_b128 v[148:151], v19 offset:32768
    s_waitcnt lgkmcnt(7)
    v_mfma_f32_16x16x32_bf16 v[20:23], v[136:139], v[136:139], v[20:23]
    ds_read_b128 v[240:243], v1 offset:12288
    ds_read_b128 v[244:247], v1 offset:13312
    v_mfma_f32_16x16x32_bf16 v[24:27], v[136:139], v[28:31], v[24:27]
    ds_read_b128 v[248:251], v1 offset:14336
    ds_read_b128 v[252:255], v1 offset:15360
    s_waitcnt lgkmcnt(10)
    v_mfma_f32_16x16x32_bf16 v[20:23], v[140:143], v[140:143], v[20:23]
    v_sin_f32_e64 v13, v13
    v_mfma_f32_16x16x32_bf16 v[24:27], v[140:143], v[28:31], v[24:27]
    v_sin_f32 v14, v14
    s_waitcnt lgkmcnt(6)
    v_mfma_f32_16x16x32_bf16 v[64:67], v[136:139], v[224:227], v[64:67]
    v_cvt_pk_f16_f32 v117, v15, v16
    v_mfma_f32_16x16x32_bf16 v[68:71], v[136:139], v[228:231], v[68:71]
    v_cvt_pk_f16_f32 v119, v13, v14
    v_mfma_f32_16x16x32_bf16 v[80:83], v[136:139], v[232:235], v[80:83]
    v_cvt_pk_f16_f32 v125, -v13, -v14
    v_mfma_f32_16x16x32_bf16 v[84:87], v[136:139], v[236:239], v[84:87]
    v_and_b32 v127, s56, v117
    s_waitcnt vmcnt(8)
    ds_read_b128 v[152:155], v18 offset:49152
    ds_read_b128 v[156:159], v19 offset:49152
    s_waitcnt lgkmcnt(7)
    v_mfma_f32_16x16x32_bf16 v[20:23], v[144:147], v[144:147], v[20:23]
    v_and_b32 v125, s56, v125
    v_mfma_f32_16x16x32_bf16 v[24:27], v[144:147], v[28:31], v[24:27]
    s_lshl_b32 s28, s3, 6
    s_waitcnt lgkmcnt(6)
    v_mfma_f32_16x16x32_bf16 v[20:23], v[148:151], v[148:151], v[20:23]
    s_add_u32 s28, s28, s94
    v_mfma_f32_16x16x32_bf16 v[24:27], v[148:151], v[28:31], v[24:27]
    v_lshl_add_u32 v8, v2, 2, s28
    s_waitcnt lgkmcnt(2)
    v_mfma_f32_16x16x32_bf16 v[64:67], v[140:143], v[240:243], v[64:67]
    v_mul_u32_u24 v9, 80, v3
    v_mfma_f32_16x16x32_bf16 v[68:71], v[140:143], v[244:247], v[68:71]
    s_bitcmp1_b32 s3, 0
    s_cselect_b32 s28, s93, s92
    v_mfma_f32_16x16x32_bf16 v[80:83], v[140:143], v[248:251], v[80:83]
    s_lshr_b32 s29, s3, 1
    v_mfma_f32_16x16x32_bf16 v[84:87], v[140:143], v[252:255], v[84:87]
    s_lshl_b32 s30, s29, 14
    v_mfma_f32_16x16x32_bf16 v[72:75], v[144:147], v[192:195], 0
    s_add_u32 s28, s28, s30
    v_mfma_f32_16x16x32_bf16 v[76:79], v[144:147], v[196:199], 0
    s_add_u32 s28, s28, 81920
    v_mfma_f32_16x16x32_bf16 v[88:91], v[144:147], v[200:203], 0
    s_lshl_b32 s29, s29, 2
    v_mfma_f32_16x16x32_bf16 v[92:95], v[144:147], v[204:207], 0
    v_xor_b32 v10, v3, v5
    s_waitcnt vmcnt(6)
    ds_read_b128 v[160:163], v60 offset:0
    ds_read_b128 v[164:167], v61 offset:0
    s_waitcnt lgkmcnt(3)
    v_mfma_f32_16x16x32_bf16 v[20:23], v[152:155], v[152:155], v[20:23]
    v_xor_b32 v10, s29, v10
    v_mfma_f32_16x16x32_bf16 v[24:27], v[152:155], v[28:31], v[24:27]
    v_lshlrev_b32 v10, 4, v10
    s_waitcnt lgkmcnt(2)
    v_mfma_f32_16x16x32_bf16 v[20:23], v[156:159], v[156:159], v[20:23]
    v_lshl_add_u32 v10, v2, 7, v10
    v_mfma_f32_16x16x32_bf16 v[24:27], v[156:159], v[28:31], v[24:27]
    v_add_u32_e64 v10, s28, v10
    v_mfma_f32_16x16x32_bf16 v[72:75], v[148:151], v[208:211], v[72:75]
    v_xor_b32_e64 v11, 64, v10
    v_mfma_f32_16x16x32_bf16 v[76:79], v[148:151], v[212:215], v[76:79]
    s_lshl_b32 s28, s3, 3
    v_mfma_f32_16x16x32_bf16 v[88:91], v[148:151], v[216:219], v[88:91]
    v_add_u32 v12, s28, v4
    v_mfma_f32_16x16x32_bf16 v[92:95], v[148:151], v[220:223], v[92:95]
    v_xor_b32 v13, v4, v5
    s_waitcnt vmcnt(4)
    ds_read_b128 v[168:171], v60 offset:16384
    ds_read_b128 v[172:175], v61 offset:16384
    s_waitcnt lgkmcnt(3)
    v_mfma_f32_16x16x32_bf16 v[20:23], v[160:163], v[160:163], v[20:23]
    v_lshlrev_b32 v13, 4, v13
    v_mfma_f32_16x16x32_bf16 v[24:27], v[160:163], v[28:31], v[24:27]
    v_lshl_add_u32 v13, v12, 7, v13
    s_waitcnt lgkmcnt(2)
    v_mfma_f32_16x16x32_bf16 v[20:23], v[164:167], v[164:167], v[20:23]
    v_add_u32 v13, 81920, v13
    v_mfma_f32_16x16x32_bf16 v[24:27], v[164:167], v[28:31], v[24:27]
    v_add_u32 v14, s93, v13
    v_mfma_f32_16x16x32_bf16 v[72:75], v[152:155], v[224:227], v[72:75]
    v_add_u32_e64 v13, s92, v13
    v_mfma_f32_16x16x32_bf16 v[76:79], v[152:155], v[228:231], v[76:79]
    v_lshlrev_b32_e64 v12, 15, v12
    v_mfma_f32_16x16x32_bf16 v[88:91], v[152:155], v[232:235], v[88:91]
    v_lshl_add_u32 v12, v5, 4, v12
    v_mfma_f32_16x16x32_bf16 v[92:95], v[152:155], v[236:239], v[92:95]
    s_lshl4_add_u32 s28, s32, s21
    v_mfma_f32_16x16x32_bf16 v[72:75], v[156:159], v[240:243], v[72:75]
    s_lshl_b32 s28, s28, 7
    v_mfma_f32_16x16x32_bf16 v[76:79], v[156:159], v[244:247], v[76:79]
    s_lshl_b32 s29, s33, 12
    v_mfma_f32_16x16x32_bf16 v[88:91], v[156:159], v[248:251], v[88:91]
    s_add_u32 s57, s28, s29
    v_mfma_f32_16x16x32_bf16 v[92:95], v[156:159], v[252:255], v[92:95]
    s_lshr_b32 s28, s2, 2
    s_waitcnt vmcnt(2)
    ds_read_b128 v[176:179], v60 offset:32768
    ds_read_b128 v[180:183], v61 offset:32768
    s_waitcnt lgkmcnt(3)
    v_mfma_f32_16x16x32_bf16 v[20:23], v[168:171], v[168:171], v[20:23]
    s_mul_i32 s28, s28, 8448
    v_mfma_f32_16x16x32_bf16 v[24:27], v[168:171], v[28:31], v[24:27]
    s_and_b32 s29, s2, 3
    s_waitcnt lgkmcnt(2)
    v_mfma_f32_16x16x32_bf16 v[20:23], v[172:175], v[172:175], v[20:23]
    s_lshl2_add_u32 s29, s29, s3
    v_mfma_f32_16x16x32_bf16 v[24:27], v[172:175], v[28:31], v[24:27]
    s_lshl_b32 s29, s29, 7
    v_mfma_f32_16x16x32_bf16 v[64:67], v[160:163], v[192:195], v[64:67]
    s_add_u32 s28, s28, s29
    v_mfma_f32_16x16x32_bf16 v[68:71], v[160:163], v[196:199], v[68:71]
    s_add_u32 s95, s28, 6881280
    v_mfma_f32_16x16x32_bf16 v[96:99], v[160:163], v[200:203], 0
    v_mov_b32_e64 v54, 0
    v_mfma_f32_16x16x32_bf16 v[100:103], v[160:163], v[204:207], 0
    v_and_b32 v53, 31, v0
    s_waitcnt vmcnt(0)
    ds_read_b128 v[184:187], v60 offset:49152
    ds_read_b128 v[188:191], v61 offset:49152
    s_waitcnt lgkmcnt(3)
    v_mfma_f32_16x16x32_bf16 v[20:23], v[176:179], v[176:179], v[20:23]
    v_lshlrev_b32 v53, 2, v53
    v_mfma_f32_16x16x32_bf16 v[24:27], v[176:179], v[28:31], v[24:27]
    s_and_b32 s9, s7, 0xffff
    s_waitcnt lgkmcnt(2)
    v_mfma_f32_16x16x32_bf16 v[20:23], v[180:183], v[180:183], v[20:23]
    s_mov_b32 s10, 0x10000000
    v_mfma_f32_16x16x32_bf16 v[24:27], v[180:183], v[28:31], v[24:27]
    s_mov_b32 s11, 0x20000
    v_mfma_f32_16x16x32_bf16 v[64:67], v[164:167], v[208:211], v[64:67]
    v_mfma_f32_16x16x32_bf16 v[68:71], v[164:167], v[212:215], v[68:71]
    v_mfma_f32_16x16x32_bf16 v[96:99], v[164:167], v[216:219], v[96:99]
    v_mfma_f32_16x16x32_bf16 v[100:103], v[164:167], v[220:223], v[100:103]
    s_waitcnt lgkmcnt(1)
    v_mfma_f32_16x16x32_bf16 v[20:23], v[184:187], v[184:187], v[20:23]
    v_mfma_f32_16x16x32_bf16 v[24:27], v[184:187], v[28:31], v[24:27]
    s_waitcnt lgkmcnt(0)
    v_mfma_f32_16x16x32_bf16 v[20:23], v[188:191], v[188:191], v[20:23]
    v_mfma_f32_16x16x32_bf16 v[24:27], v[188:191], v[28:31], v[24:27]
    s_mov_b32 s96, 6651776
    buffer_load_dword v55, off, s[8:11], s96 sc1
    buffer_store_dword v54, v53, s[8:11], s95 offen sc1
    v_mfma_f32_16x16x32_bf16 v[64:67], v[168:171], v[224:227], v[64:67]
    v_mfma_f32_16x16x32_bf16 v[68:71], v[168:171], v[228:231], v[68:71]
    v_mfma_f32_16x16x32_bf16 v[96:99], v[168:171], v[232:235], v[96:99]
    v_mfma_f32_16x16x32_bf16 v[100:103], v[168:171], v[236:239], v[100:103]
    v_mfma_f32_16x16x32_bf16 v[64:67], v[172:175], v[240:243], v[64:67]
    v_cndmask_b32 v20, v20, v21, s[50:51]
    v_cndmask_b32 v22, v22, v23, s[50:51]
    v_mfma_f32_16x16x32_bf16 v[68:71], v[172:175], v[244:247], v[68:71]
    v_cndmask_b32 v20, v20, v22, s[52:53]
    v_cndmask_b32 v24, v24, v25, s[50:51]
    v_mfma_f32_16x16x32_bf16 v[96:99], v[172:175], v[248:251], v[96:99]
    v_cndmask_b32 v26, v26, v27, s[50:51]
    v_cndmask_b32 v24, v24, v26, s[52:53]
    v_mfma_f32_16x16x32_bf16 v[100:103], v[172:175], v[252:255], v[100:103]
    v_mul_f32 v24, 0xbb000000, v24
    v_mul_f32 v20, 0x3b000000, v20
    v_mfma_f32_16x16x32_bf16 v[72:75], v[176:179], v[192:195], v[72:75]
    v_fma_f32 v20, -v24, v24, v20
    v_max_f32 v20, 0, v20
    v_mfma_f32_16x16x32_bf16 v[76:79], v[176:179], v[196:199], v[76:79]
    v_add_f32 v20, 0x3727c5ac, v20
    v_rsq_f32_e64 v20, v20
    v_mfma_f32_16x16x32_bf16 v[104:107], v[176:179], v[200:203], 0
    s_nop 0
    v_mul_f32 v20, s61, v20
    v_mfma_f32_16x16x32_bf16 v[108:111], v[176:179], v[204:207], 0
    v_fmac_f32 v80, v17, v92
    v_fmac_f32 v81, v17, v93
    v_mfma_f32_16x16x32_bf16 v[72:75], v[180:183], v[208:211], v[72:75]
    v_mov_b32_dpp v28, v20 row_newbcast:0 row_mask:0x1 bank_mask:0xf
    v_mov_b32_dpp v29, v20 row_newbcast:1 row_mask:0x1 bank_mask:0xf
    v_mfma_f32_16x16x32_bf16 v[76:79], v[180:183], v[212:215], v[76:79]
    v_mov_b32_dpp v30, v20 row_newbcast:2 row_mask:0x1 bank_mask:0xf
    v_mov_b32_dpp v31, v20 row_newbcast:3 row_mask:0x1 bank_mask:0xf
    v_mfma_f32_16x16x32_bf16 v[104:107], v[180:183], v[216:219], v[104:107]
    v_mov_b32_dpp v28, v20 row_newbcast:4 row_mask:0x2 bank_mask:0xf
    v_mov_b32_dpp v29, v20 row_newbcast:5 row_mask:0x2 bank_mask:0xf
    v_mfma_f32_16x16x32_bf16 v[108:111], v[180:183], v[220:223], v[108:111]
    v_mov_b32_dpp v30, v20 row_newbcast:6 row_mask:0x2 bank_mask:0xf
    v_mov_b32_dpp v31, v20 row_newbcast:7 row_mask:0x2 bank_mask:0xf
    v_mfma_f32_16x16x32_bf16 v[72:75], v[184:187], v[224:227], v[72:75]
    v_mov_b32_dpp v28, v20 row_newbcast:8 row_mask:0x4 bank_mask:0xf
    v_mov_b32_dpp v29, v20 row_newbcast:9 row_mask:0x4 bank_mask:0xf
    v_mfma_f32_16x16x32_bf16 v[76:79], v[184:187], v[228:231], v[76:79]
    v_mov_b32_dpp v30, v20 row_newbcast:10 row_mask:0x4 bank_mask:0xf
    v_mov_b32_dpp v31, v20 row_newbcast:11 row_mask:0x4 bank_mask:0xf
    v_mfma_f32_16x16x32_bf16 v[104:107], v[184:187], v[232:235], v[104:107]
    v_mov_b32_dpp v28, v20 row_newbcast:12 row_mask:0x8 bank_mask:0xf
    v_mov_b32_dpp v29, v20 row_newbcast:13 row_mask:0x8 bank_mask:0xf
    v_mfma_f32_16x16x32_bf16 v[108:111], v[184:187], v[236:239], v[108:111]
    v_mov_b32_dpp v30, v20 row_newbcast:14 row_mask:0x8 bank_mask:0xf
    v_mov_b32_dpp v31, v20 row_newbcast:15 row_mask:0x8 bank_mask:0xf
    v_mfma_f32_16x16x32_bf16 v[72:75], v[188:191], v[240:243], v[72:75]
    v_fmac_f32 v82, v17, v94
    v_fmac_f32 v83, v17, v95
    v_mfma_f32_16x16x32_bf16 v[76:79], v[188:191], v[244:247], v[76:79]
    v_fma_f32 v84, -v17, v88, v84
    v_fma_f32 v85, -v17, v89, v85
    v_mfma_f32_16x16x32_bf16 v[104:107], v[188:191], v[248:251], v[104:107]
    v_fma_f32 v86, -v17, v90, v86
    v_fma_f32 v87, -v17, v91, v87
    v_mfma_f32_16x16x32_bf16 v[108:111], v[188:191], v[252:255], v[108:111]
    v_sub_f32 v80, v80, v96
    v_sub_f32 v81, v81, v97
    v_sub_f32 v82, v82, v98
    v_sub_f32 v83, v83, v99
    v_sub_f32 v84, v84, v100
    v_sub_f32 v85, v85, v101
    v_sub_f32 v86, v86, v102
    v_sub_f32 v87, v87, v103
    v_mul_f32 v48, v17, v28
    v_mul_f32 v49, v17, v29
    v_mul_f32 v50, v17, v30
    v_mul_f32 v51, v17, v31
    v_mul_f32 v64, v64, v28
    v_mul_f32 v65, v65, v29
    v_mul_f32 v66, v66, v30
    v_mul_f32 v67, v67, v31
    v_mul_f32 v68, v68, v28
    v_mul_f32 v69, v69, v29
    v_mul_f32 v70, v70, v30
    v_mul_f32 v71, v71, v31
    v_mul_f32 v80, v80, v28
    v_mul_f32 v81, v81, v29
    v_mul_f32 v82, v82, v30
    v_mul_f32 v83, v83, v31
    v_mul_f32 v84, v84, v28
    v_mul_f32 v85, v85, v29
    v_mul_f32 v86, v86, v30
    v_mul_f32_e64 v87, v87, v31
    s_mov_b64 exec, s[54:55]
    ds_write2st64_b32 v8, v20, v24 offset0:0 offset1:2
    s_mov_b64 exec, -1
    v_fmac_f32 v64, v48, v72
    v_fmac_f32 v65, v49, v73
    v_fmac_f32 v66, v50, v74
    v_fmac_f32 v67, v51, v75
    v_fmac_f32 v68, v48, v76
    v_fmac_f32 v69, v49, v77
    v_fmac_f32 v70, v50, v78
    v_fmac_f32_e64 v71, v51, v79
    v_cvt_pk_f16_f32 v32, v64, v65
    v_cvt_pk_f16_f32 v33, v66, v67
    v_cvt_pk_f16_f32 v34, v68, v69
    v_cvt_pk_f16_f32 v35, v70, v71
    v_fma_f32 v80, -v48, v108, v80
    v_fma_f32 v81, -v49, v109, v81
    v_mfma_f32_16x16x32_f16 v[128:131], v[32:35], v[112:115], 0
    v_fma_f32 v82, -v50, v110, v82
    v_fma_f32 v83, -v51, v111, v83
    v_fmac_f32 v84, v48, v104
    v_fmac_f32 v85, v49, v105
    v_mfma_f32_16x16x32_f16 v[136:139], v[32:35], v[116:119], 0
    v_fmac_f32 v86, v50, v106
    v_fmac_f32 v87, v51, v107
    v_cvt_pk_f16_f32 v36, v80, v81
    v_cvt_pk_f16_f32 v37, v82, v83
    v_mfma_f32_16x16x32_f16 v[144:147], v[32:35], v[120:123], 0
    v_cvt_pk_f16_f32 v38, v84, v85
    v_cvt_pk_f16_f32 v39, v86, v87
    v_mfma_f32_16x16x32_f16 v[152:155], v[32:35], v[124:127], 0
    s_nop 0
    v_mfma_f32_16x16x32_f16 v[132:135], v[36:39], v[112:115], 0
    v_mfma_f32_16x16x32_f16 v[140:143], v[36:39], v[116:119], 0
    v_mfma_f32_16x16x32_f16 v[148:151], v[36:39], v[120:123], 0
    v_mfma_f32_16x16x32_f16 v[156:159], v[36:39], v[124:127], 0
    s_nop 4
    v_cvt_pk_f16_f32 v64, v128, v132
    v_cvt_pk_f16_f32 v65, v129, v133
    v_cvt_pk_f16_f32 v66, v130, v134
    v_cvt_pk_f16_f32 v67, v131, v135
    ds_write_b128 v10, v[64:67] offset:0
    v_cvt_pk_f16_f32 v68, v136, v140
    v_cvt_pk_f16_f32 v69, v137, v141
    v_cvt_pk_f16_f32 v70, v138, v142
    v_cvt_pk_f16_f32 v71, v139, v143
    ds_write_b128 v10, v[68:71] offset:2048
    v_cvt_pk_f16_f32 v72, v144, v148
    v_cvt_pk_f16_f32 v73, v145, v149
    v_cvt_pk_f16_f32 v74, v146, v150
    v_cvt_pk_f16_f32 v75, v147, v151
    ds_write_b128 v11, v[72:75] offset:0
    v_cvt_pk_f16_f32 v76, v152, v156
    v_cvt_pk_f16_f32 v77, v153, v157
    v_cvt_pk_f16_f32 v78, v154, v158
    v_cvt_pk_f16_f32 v79, v155, v159
    ds_write_b128 v11, v[76:79] offset:2048
    s_waitcnt lgkmcnt(0)
    s_barrier
    ds_read_b128 v[32:35], v13 offset:0
    ds_read_b128 v[36:39], v14 offset:0
    ds_read_b128 v[40:43], v13 offset:16384
    ds_read_b128 v[44:47], v14 offset:16384
    s_waitcnt lgkmcnt(2)
    v_pk_add_f16 v32, v32, v36
    v_pk_add_f16 v33, v33, v37
    v_pk_add_f16 v34, v34, v38
    v_pk_add_f16 v35, v35, v39
    s_waitcnt lgkmcnt(0)
    v_pk_add_f16 v40, v40, v44
    v_pk_add_f16 v41, v41, v45
    v_pk_add_f16 v42, v42, v46
    v_pk_add_f16 v43, v43, v47
    v_pk_add_f16 v32, v32, v40
    v_pk_add_f16 v33, v33, v41
    v_pk_add_f16 v34, v34, v42
    v_pk_add_f16 v35, v35, v43
    buffer_store_dwordx4 v[32:35], v12, s[8:11], s57 offen sc1
    s_setprio 2
    s_lshl3_add_u32 s22, s32, s33
    s_lshr_b32 s26, s20, 1
    s_xor_b32 s29, s26, 1
    s_cmp_eq_u32 s21, 0
    s_cselect_b32 s27, s26, s29
    s_cmp_eq_u32 s26, 0
    s_cselect_b32 s23, s21, s31
    s_lshl_b32 s28, s24, 5
    s_add_u32 s25, s23, s28
    s_mov_b32 s35, 0
    s_and_b32 s28, s2, 0
    s_lshl_b32 s28, s28, 11
    s_add_u32 s6, s6, s28
    s_addc_u32 s7, s7, 0
    v_and_b32 v12, 15, v0
    v_lshrrev_b32 v13, 4, v0
    v_lshlrev_b32 v56, 3, v13
    v_and_b32 v46, 31, v0
    v_lshlrev_b32 v46, 10, v46
    v_lshlrev_b32_e64 v47, 4, v12
    s_lshr_b32 s28, s23, 2
    s_lshl_b32 s28, s28, 7
    s_and_b32 s29, s23, 3
    s_lshl3_add_u32 s28, s29, s28
    s_add_u32 s16, s28, 6553600
    s_lshl_b32 s29, s25, 9
    s_add_u32 s17, s29, 6848512
    s_cmp_eq_u32 s23, 0
    s_cselect_b32 s30, 64, 63
    v_cvt_f32_u32 v58, v13
    v_add_f32 v58, v58, v58
    v_cmp_eq_u32_e64 vcc, 0, v13
    s_brev_b32 s34, 1
    v_lshl_add_u32 v59, v12, 1, s24
    v_lshlrev_b32 v60, 30, v59
    v_cvt_f32_u32 v59, v59
    v_and_or_b32 v60, v60, s34, 1.0
    v_mul_f32 v59, 0x3c800000, v59
    v_mul_f32 v61, v59, v58
    v_add_f32 v62, v61, v59
    v_fmamk_f32 v63, v59, 0x41000000, v61
    v_fmamk_f32 v64, v59, 0x41000000, v62
    v_sin_f32 v65, v61
    v_sin_f32 v66, v62
    v_sin_f32 v67, v63
    v_sin_f32 v68, v64
    v_cos_f32 v61, v61
    v_cos_f32 v62, v62
    v_cos_f32 v63, v63
    v_cos_f32 v64, v64
    v_cndmask_b32_e64 v65, v65, v60, vcc
    v_cvt_pk_f16_f32 v240, v61, v65
    v_cvt_pk_f16_f32 v241, v62, v66
    v_cvt_pk_f16_f32 v242, v63, v67
    v_cvt_pk_f16_f32 v243, v64, v68
    v_pk_add_f16 v240, v240, v240
    v_pk_add_f16 v241, v241, v241
    v_pk_add_f16 v242, v242, v242
    v_pk_add_f16 v243, v243, v243
    v_lshl_add_u32 v59, v12, 1, s24
    v_add_u32 v59, 32, v59
    v_lshlrev_b32 v60, 30, v59
    v_cvt_f32_u32_e64 v59, v59
    v_and_or_b32 v60, v60, s34, 1.0
    v_mul_f32 v59, 0x3c800000, v59
    v_mul_f32 v61, v59, v58
    v_add_f32 v62, v61, v59
    v_fmamk_f32 v63, v59, 0x41000000, v61
    v_fmamk_f32 v64, v59, 0x41000000, v62
    v_sin_f32 v65, v61
    v_sin_f32 v66, v62
    v_sin_f32 v67, v63
    v_sin_f32 v68, v64
    v_cos_f32 v61, v61
    v_cos_f32 v62, v62
    v_cos_f32 v63, v63
    v_cos_f32 v64, v64
    v_cndmask_b32_e64 v65, v65, v60, vcc
    v_cvt_pk_f16_f32 v244, v61, v65
    v_cvt_pk_f16_f32 v245, v62, v66
    v_cvt_pk_f16_f32 v246, v63, v67
    v_cvt_pk_f16_f32 v247, v64, v68
    v_pk_add_f16 v244, v244, v244
    v_pk_add_f16 v245, v245, v245
    v_pk_add_f16 v246, v246, v246
    v_pk_add_f16 v247, v247, v247
    v_lshl_add_u32 v59, v12, 1, s24
    v_sub_u32 v59, s30, v59
    v_lshlrev_b32 v60, 30, v59
    v_cvt_f32_u32_e64 v59, v59
    v_and_or_b32 v60, v60, s34, 1.0
    v_mul_f32 v59, 0x3c800000, v59
    v_mul_f32 v61, v59, v58
    v_add_f32 v62, v61, v59
    v_fmamk_f32 v63, v59, 0x41000000, v61
    v_fmamk_f32 v64, v59, 0x41000000, v62
    v_sin_f32 v65, v61
    v_sin_f32 v66, v62
    v_sin_f32 v67, v63
    v_sin_f32 v68, v64
    v_cos_f32 v61, v61
    v_cos_f32 v62, v62
    v_cos_f32 v63, v63
    v_cos_f32 v64, v64
    v_cndmask_b32_e64 v65, v65, v60, vcc
    v_cvt_pk_f16_f32 v16, v61, v65
    v_cvt_pk_f16_f32 v17, v62, v66
    v_cvt_pk_f16_f32 v18, v63, v67
    v_cvt_pk_f16_f32 v19, v64, v68
    v_pk_add_f16 v16, v16, v16
    v_pk_add_f16 v17, v17, v17
    v_pk_add_f16 v18, v18, v18
    v_pk_add_f16 v19, v19, v19
    v_lshl_add_u32 v59, v12, 1, s24
    v_add_u32 v59, 32, v59
    v_sub_u32 v59, s30, v59
    v_lshlrev_b32 v60, 30, v59
    v_cvt_f32_u32 v59, v59
    v_and_or_b32 v60, v60, s34, 1.0
    v_mul_f32 v59, 0x3c800000, v59
    s_waitcnt vmcnt(0)
    s_barrier
    v_mul_f32 v61, v59, v58
    v_add_f32 v62, v61, v59
    v_fmamk_f32 v63, v59, 0x41000000, v61
    v_fmamk_f32 v64, v59, 0x41000000, v62
    v_sin_f32 v65, v61
    v_sin_f32 v66, v62
    v_sin_f32 v67, v63
    v_sin_f32 v68, v64
    v_cos_f32 v61, v61
    v_cos_f32 v62, v62
    v_cos_f32 v63, v63
    v_cos_f32 v64, v64
    v_cndmask_b32_e64 v65, v65, v60, vcc
    v_cvt_pk_f16_f32 v20, v61, v65
    v_cvt_pk_f16_f32 v21, v62, v66
    v_cvt_pk_f16_f32 v22, v63, v67
    v_cvt_pk_f16_f32 v23, v64, v68
    v_pk_add_f16 v20, v20, v20
    v_pk_add_f16 v21, v21, v21
    v_pk_add_f16 v22, v22, v22
    v_pk_add_f16 v23, v23, v23
    v_mov_b32 v59, 0x10000
    v_cndmask_b32 v10, 0, v59, vcc
    v_sub_u32 v59, v12, v56
    v_lshlrev_b32_e64 v61, 4, v59
    v_mov_b32 v62, 0x3f80
    v_lshlrev_b32 v61, v61, v62
    v_ashrrev_i32 v60, 1, v59
    v_cmp_eq_u32 s[40:41], 0, v60
    v_cmp_eq_u32 s[42:43], 1, v60
    v_cmp_eq_u32 s[44:45], 2, v60
    v_cmp_eq_u32 s[46:47], 3, v60
    v_cmp_eq_u32 s[48:49], -8, v60
    v_cmp_eq_u32 s[50:51], -7, v60
    v_cmp_eq_u32 s[52:53], -6, v60
    v_cmp_eq_u32 s[54:55], -5, v60
    v_cndmask_b32 v248, 0, v61, s[40:41]
    v_cndmask_b32 v249, 0, v61, s[42:43]
    v_cndmask_b32 v250, 0, v61, s[44:45]
    v_cndmask_b32 v251, 0, v61, s[46:47]
    v_cndmask_b32 v252, 0, v61, s[48:49]
    v_cndmask_b32 v253, 0, v61, s[50:51]
    v_cndmask_b32 v254, 0, v61, s[52:53]
    v_cndmask_b32 v255, 0, v61, s[54:55]
    v_add_u32 v59, v12, v56
    v_sub_u32 v59, 32, v59
    v_lshlrev_b32_e64 v61, 4, v59
    v_mov_b32 v62, 0x3f80
    v_lshlrev_b32 v61, v61, v62
    v_ashrrev_i32 v60, 1, v59
    v_cmp_eq_u32 s[40:41], 0, v60
    v_cmp_eq_u32 s[42:43], 1, v60
    v_cmp_eq_u32 s[44:45], 2, v60
    v_cmp_eq_u32 s[46:47], 3, v60
    v_cmp_eq_u32 s[48:49], 8, v60
    v_cmp_eq_u32 s[50:51], 9, v60
    v_cmp_eq_u32 s[52:53], 10, v60
    v_cmp_eq_u32 s[54:55], 11, v60
    v_cndmask_b32 v24, 0, v61, s[40:41]
    v_cndmask_b32 v25, 0, v61, s[42:43]
    v_cndmask_b32 v26, 0, v61, s[44:45]
    v_cndmask_b32 v27, 0, v61, s[46:47]
    v_cndmask_b32 v28, 0, v61, s[48:49]
    v_cndmask_b32 v29, 0, v61, s[50:51]
    v_cndmask_b32 v30, 0, v61, s[52:53]
    v_cndmask_b32 v31, 0, v61, s[54:55]
    v_cmp_ne_u32 vcc, 0, v12
    v_lshrrev_b32 v59, 2, v0
    v_lshlrev_b32_e64 v59, 6, v59
    v_cndmask_b32 v11, 0, -1, vcc
    v_and_b32_e64 v60, 3, v0
    v_lshl_add_u32 v59, v60, 3, v59
    v_and_b32_e64 v60, 1, v13
    v_lshl_add_u32 v59, v60, 5, v59
    s_lshl_b32 s28, s26, 13
    v_add_u32 v2, s28, v59
    s_lshl_b32 s28, s27, 13
    v_add_u32 v4, s28, v59
    s_mul_i32 s92, s24, 0x80008000
    s_or_b32 s92, s92, 0x3c003c00
    buffer_load_dwordx2 v[96:97], v46, s[8:11], s16 offen sc1
    buffer_load_dwordx4 v[88:91], v47, s[8:11], s17 offen offset:0 sc1
    buffer_load_dwordx4 v[92:95], v47, s[8:11], s17 offen offset:256 sc1
    s_and_b32 s29, s30, 1
    s_mul_i32 s29, s29, 0x80008000
    s_xor_b32 s93, s92, s29
    v_xor_b32 v3, 32, v2
    v_xor_b32 v5, 32, v4
    v_lshrrev_b32 v59, 1, v12
    v_xor_b32 v59, v13, v59
    v_lshlrev_b32_e64 v59, 4, v59
    v_lshl_add_u32 v59, v12, 7, v59
    s_lshl_b32 s28, s20, 12
    s_add_u32 s28, s28, 32768
    v_add_u32 v6, s28, v59
    v_xor_b32_e64 v7, 64, v6
    v_add_u32 v44, 65536, v6
    v_add_u32 v45, 65536, v7
    s_mul_i32 s28, s25, 114688
    s_add_u32 s28, s28, 8388608
    s_lshl_b32 s29, s22, 10
    s_add_u32 s36, s28, s29
    s_add_u32 s37, s36, 57344
    s_mul_i32 s29, s32, 57344
    s_add_u32 s59, s28, s29
    s_mul_i32 s28, s25, 8448
    s_add_u32 s28, s28, 6881280
    s_add_u32 s60, s6, s28
    s_addc_u32 s61, s7, 0
    s_lshr_b32 s29, s22, 2
    s_mul_i32 s29, s29, 512
    s_add_u32 s56, s28, s29
    s_and_b32 s29, s22, 3
    s_lshl_b32 s29, s29, 2
    s_add_u32 s56, s56, s29
    s_lshl_b32 s28, s33, 4
    s_sub_u32 s29, 176, s28
    s_cmp_ge_u32 s33, 4
    s_cselect_b32 s28, s29, s28
    s_cselect_b32 s14, -1, 1
    s_cselect_b32 s15, 64, 0
    s_add_u32 s29, s28, 16
    s_cmp_eq_u32 s33, 4
    s_cselect_b32 s29, 64, s29
    s_lshl_b32 s30, s32, 2
    s_add_u32 s12, s28, s30
    s_add_u32 s13, s29, s30
    s_add_u32 s94, s59, 32768
    s_add_u32 s95, s59, 36864
    s_add_u32 s96, s59, 40960
    s_add_u32 s97, s59, 45056
    s_lshl_b32 s28, s20, 2
    s_lshr_b32 s28, 0x9874, s28
    s_and_b32 s28, s28, 15
    s_lshl_b32 s98, s28, 14
    s_lshl_b32 s28, s22, 9
    s_sub_u32 s99, s36, s28
    s_add_u32 s99, s99, 49152
    v_add_u32 v14, 65536, v1
    v_add_u32 v15, 131072, v1
    s_mov_b32 s28, 0x9e3779b1
    v_mul_lo_u32 v55, v55, s28
    v_add_u32 v55, 0x7f4a7c15, v55
    s_mov_b32 s40, 0x05040100
    s_mov_b32 s41, 0x07060302
    s_branch L_g1
L_mover2:
    s_lshr_b32 s28, s2, 3
    s_lshl_b32 s28, s28, 7
    s_add_u32 s4, s4, s28
    s_lshl_b32 s4, s4, 10
    s_add_u32 s4, s4, 1048576
    s_cmp_ge_u32 s2, 224
    s_cselect_b32 s4, 536870912, s4
    v_bfe_u32 v32, v0, 2, 2
    v_and_b32 v33, 3, v0
    v_lshlrev_b32 v32, 7, v32
    v_add_u32 v32, s37, v32
    v_lshl_add_u32 v32, v33, 3, v32
    v_lshl_add_u32 v32, v3, 9, v32
    s_and_b32 s28, s95, 7
    s_mul_i32 s28, s28, 56
    s_lshr_b32 s29, s95, 3
    s_add_u32 s28, s28, s29
    s_lshl_b32 s28, s28, 12
    s_add_u32 s36, s28, 4718592
    s_lshl_b32 s28, s95, 7
    s_add_u32 s28, s28, 6651904
    s_cmp_lt_u32 s20, 2
    s_cselect_b32 s95, 448, s95
    s_cmp_ge_u32 s95, 448
    s_cselect_b32 s36, 536870912, s36
    s_cselect_b32 s95, 536870912, s28
    s_mov_b32 s52, 0x05040100
    s_mov_b32 s53, 0x07060302
    v_mov_b32 v41, 0
    s_cmp_ge_u32 s20, 2
    s_cbranch_scc1 L_g2
    v_lshlrev_b32_e64 v47, 2, v0
    s_lshl_b32 s28, s32, 5
    s_add_u32 s48, s28, s21
    s_cmp_eq_u32 s48, 0
    s_cselect_b32 s58, 0, 1.0
    s_cselect_b32 s60, 0, 0xbe800000
    s_cmp_eq_u32 s48, 32
    s_cselect_b32 s60, 0xbe000000, s60
    s_cselect_b32 s59, 0xbe000000, 0
    s_cselect_b32 s61, 0x3eb504f3, 0.5
    s_cselect_b32 s48, 48, s48
    s_sub_u32 s28, 4, s34
    s_cmp_eq_u32 s32, 0
    s_cselect_b32 s92, s28, 0
    s_cselect_b32 s93, 2, s34
    s_lshl_b32 s92, s92, 12
    s_lshl_b32 s93, s93, 12
    s_add_u32 s94, s92, 114688
    s_sub_u32 s28, 64, s48
    s_cmp_eq_u32 s48, 0
    s_cselect_b32 s49, 32, s28
    s_lshl_b32 s28, s33, 2
    v_add_u32 v41, s28, v3
    v_cvt_f32_u32 v42, v41
    v_mul_f32 v42, 0x3a000000, v42
    v_lshl_add_u32 v43, v2, 6, s48
    v_cvt_f32_u32_e64 v43, v43
    v_fma_f32 v43, v43, v42, s59
    v_fmamk_f32 v48, v42, 0x44800000, v43
    v_cos_f32 v50, v43
    v_cos_f32 v51, v48
    v_sin_f32 v52, v43
    v_sin_f32 v53, v48
    v_lshl_add_u32 v43, v2, 6, s49
    v_cvt_f32_u32_e64 v43, v43
    v_fma_f32 v43, v43, v42, s60
    v_fmamk_f32 v48, v42, 0x44800000, v43
    v_cos_f32 v54, v43
    v_cos_f32 v55, v48
    v_sin_f32 v56, v43
    v_sin_f32 v57, v48
    v_lshlrev_b32 v40, 2, v2
    v_add_u32 v40, s94, v40
    v_add_u32 v104, 0, v40
    v_add_u32 v105, 64, v40
    v_add_u32 v106, 128, v40
    v_add_u32 v107, 192, v40
    v_add_u32 v47, s94, v47
    s_sub_u32 s28, 4, s34
    s_cmp_eq_u32 s32, 0
    s_cselect_b32 s28, 0, s28
    s_cselect_b32 s29, s34, 2
    s_lshl_b32 s28, s28, 12
    s_lshl_b32 s29, s29, 12
    v_lshrrev_b32 v36, 1, v2
    v_lshlrev_b32_e64 v36, 4, v36
    v_lshl_add_u32 v36, v2, 7, v36
    v_add_u32 v37, s29, v36
    v_add_u32 v36, s28, v36
    v_mov_b32 v34, s48
    v_mov_b32 v35, s49
    v_cmp_gt_u32 vcc, 32, v0
    v_and_b32 v33, 31, v0
    v_lshlrev_b32 v33, 4, v33
    v_cndmask_b32 v34, v35, v34, vcc
    v_cndmask_b32 v38, v37, v36, vcc
    v_and_b32 v39, 16, v0
    v_lshl_add_u32 v38, v39, 7, v38
    v_add_u32 v38, 98304, v38
    v_lshl_add_u32 v33, v34, 9, v33
    s_cmp_eq_u32 s33, 0
    s_mov_b32 s50, 6848512
    s_cselect_b32 s50, s50, 536870912
    v_lshlrev_b32_e64 v41, 3, v3
    s_lshl4_add_u32 s28, s32, s21
    s_lshl3_add_u32 s28, s28, s33
    s_lshl_b32 s28, s28, 7
    s_add_u32 s51, s28, 6553600
L_g2:
    s_waitcnt vmcnt(13)
    s_cmp_ge_u32 s20, 2
    s_cbranch_scc1 L_w1_1
    s_waitcnt vmcnt(5)
L_w1_1:
    s_cselect_b32 s29, 8, 0
    s_mov_b32 s28, 0x9e3779b1
    v_mul_lo_u32 v10, v19, s28
    v_add_u32 v10, 0x7f4a7c15, v10
    s_movk_i32 s5, 12
L_w1l:
    s_getreg_b32 s28, hwreg(HW_REG_IB_STS, 0, 4)
    s_cmp_le_u32 s28, s29
    s_cbranch_scc1 L_w1g
    s_sleep 1
    s_sub_u32 s5, s5, 1
    s_cbranch_scc0 L_w1l
    s_branch L_w1e
L_w1g:
    s_waitcnt vmcnt(8)
    s_cmp_ge_u32 s20, 2
    s_cbranch_scc1 L_w1_2
    s_waitcnt vmcnt(0)
L_w1_2:
    ds_read_b64_tr_b16 v[64:65], v32 offset:0
    ds_read_b64_tr_b16 v[66:67], v32 offset:2048
    ds_read_b64_tr_b16 v[68:69], v32 offset:32
    ds_read_b64_tr_b16 v[70:71], v32 offset:2080
    ds_read_b64_tr_b16 v[72:73], v32 offset:64
    ds_read_b64_tr_b16 v[74:75], v32 offset:2112
    ds_read_b64_tr_b16 v[76:77], v32 offset:96
    ds_read_b64_tr_b16 v[78:79], v32 offset:2144
    s_waitcnt lgkmcnt(6)
    buffer_store_dwordx4 v[64:67], v1, s[8:11], s4 offen sc1
    s_add_u32 s4, s4, 32768
    s_waitcnt lgkmcnt(4)
    buffer_store_dwordx4 v[68:71], v1, s[8:11], s4 offen sc1
    s_add_u32 s4, s4, 32768
    s_waitcnt lgkmcnt(2)
    buffer_store_dwordx4 v[72:75], v1, s[8:11], s4 offen sc1
    s_add_u32 s4, s4, 32768
    s_waitcnt lgkmcnt(0)
    buffer_store_dwordx4 v[76:79], v1, s[8:11], s4 offen sc1
L_w1e:
    s_lshl4_add_u32 s28, s32, s21
    s_and_b32 s29, s33, 1
    s_lshl1_add_u32 s28, s28, s29
    s_lshl_b32 s28, s28, 8
    s_lshr_b32 s29, s33, 1
    s_lshl_b32 s29, s29, 2
    s_add_u32 s28, s29, s28
    s_add_u32 s28, s28, 6586368
    s_cmp_eq_u32 s20, 2
    s_cselect_b32 s57, s28, 536870912
    s_lshl3_add_u32 s22, s32, s33
    s_lshr_b32 s26, s20, 1
    s_xor_b32 s29, s26, 1
    s_cmp_eq_u32 s21, 0
    s_cselect_b32 s27, s26, s29
    s_cmp_eq_u32 s26, 0
    s_cselect_b32 s23, s21, s31
    s_lshl_b32 s28, s24, 5
    s_add_u32 s25, s23, s28
    s_mov_b32 s35, 0
    s_and_b32 s28, s2, 0
    s_lshl_b32 s28, s28, 11
    s_add_u32 s6, s6, s28
    s_addc_u32 s7, s7, 0
    v_min_u32 v12, 13, v0
    v_lshrrev_b32 v13, 2, v12
    v_and_b32 v14, 3, v12
    v_lshl_add_u32 v13, v13, 4, v14
    s_lshl_b32 s28, s20, 2
    v_add_u32 v13, s28, v13
    v_lshl_add_u32 v14, v12, 2, s20
    v_cmp_gt_u32 vcc, 8, v12
    s_lshl_b32 s28, s33, 7
    s_add_u32 s56, s28, 6651904
    v_cndmask_b32 v12, v14, v13, vcc
    v_lshlrev_b32_e64 v12, 10, v12
    s_lshl_b32 s28, s2, 8
    s_lshl_b32 s29, s20, 2
    s_add_u32 s28, s28, s29
    s_add_u32 s55, s28, 6717440
    s_mul_i32 s28, s22, 7
    s_add_u32 s29, s28, 6
    s_lshr_b32 s28, s28, 2
    s_lshr_b32 s29, s29, 2
    v_add_u32 v14, s28, v4
    v_min_u32 v14, s29, v14
    v_lshlrev_b32 v14, 11, v14
    v_and_b32 v15, 4, v0
    v_lshl_add_u32 v14, v15, 8, v14
    v_and_b32_e64 v15, 3, v0
    v_lshl_add_u32 v14, v15, 2, v14
    s_lshl_b32 s28, s20, 8
    s_add_u32 s54, s28, 6717440
    s_lshl_b32 s92, s20, 12
    s_lshl_b32 s28, s23, 15
    s_lshl_b32 s29, s24, 12
    s_add_u32 s93, s28, s29
    v_and_b32 v8, 16, v0
    v_lshlrev_b32 v8, 1, v8
    v_xor_b32 v8, v8, v1
    v_lshrrev_b32 v11, 2, v0
    v_cmp_eq_u32 vcc, 1, v11
    v_cmp_eq_u32 s[40:41], 0, v11
    v_add_u32 v2, 1984, v8
    v_add_u32 v3, 2048, v8
    v_add_u32 v11, 64, v8
    v_cndmask_b32 v2, v8, v2, vcc
    v_cndmask_b32 v3, v3, v11, s[40:41]
    s_mul_i32 s37, s22, 229376
    s_add_u32 s37, s37, s92
    s_mul_i32 s28, s33, 229376
    s_add_u32 s96, s28, s92
    s_lshl_b32 s29, s20, 14
    s_add_u32 s97, s28, s29
    s_lshl_b32 s28, s24, 8
    s_add_u32 s94, s28, 6586368
    v_lshrrev_b32 v9, 1, v0
    v_lshlrev_b32 v9, 9, v9
    v_and_b32 v11, 1, v0
    v_lshl_add_u32 v9, v11, 2, v9
    s_cmp_ge_u32 s20, 2
    s_barrier
    s_cbranch_scc1 L_g2b
    s_cmp_eq_u32 s20, 0
    s_cbranch_scc1 L_h0
    ds_read_b32 v60, v47 offset:512
    ds_read_u16 v62, v38
    v_mov_b32 v61, v10
    v_mov_b32 v63, v10
    s_waitcnt lgkmcnt(0)
    buffer_store_dwordx4 v[60:63], v33, s[8:11], s50 offen sc1
    s_branch L_g2b
L_h0:
    ds_read_u16 v60, v36 offset:32768
    ds_read2st64_b32 v[96:97], v104 offset0:0 offset1:2
    ds_read_u16 v61, v36 offset:34816
    ds_read2st64_b32 v[98:99], v105 offset0:0 offset1:2
    ds_read_u16 v62, v37 offset:32768
    ds_read2st64_b32 v[100:101], v106 offset0:0 offset1:2
    ds_read_u16 v63, v37 offset:34816
    ds_read2st64_b32 v[102:103], v107 offset0:0 offset1:2
    s_waitcnt lgkmcnt(0)
    v_lshlrev_b32 v60, 16, v60
    v_add_f32 v60, v60, v97
    v_mul_f32 v60, v60, v96
    v_lshlrev_b32 v61, 16, v61
    v_add_f32 v61, v61, v99
    v_mul_f32 v61, v61, v98
    v_lshlrev_b32 v62, 16, v62
    v_add_f32 v62, v62, v101
    v_mul_f32 v62, v62, v100
    v_lshlrev_b32 v63, 16, v63
    v_add_f32 v63, v63, v103
    v_mul_f32 v63, v63, v102
    v_mul_f32 v58, v56, v62
    v_mul_f32 v59, v52, v60
    v_fmac_f32 v58, v57, v63
    v_fmac_f32 v59, v53, v61
    v_mul_f32 v58, s58, v58
    v_mul_f32 v59, s58, v59
    v_fma_f32 v58, -v50, v60, v58
    v_fma_f32 v59, -v54, v62, v59
    v_fma_f32 v58, -v51, v61, v58
    v_fma_f32 v59, -v55, v63, v59
    s_nop 0
    v_add_f32_dpp v58, v58, v58 row_ror:8 row_mask:0xf bank_mask:0xf
    v_add_f32_dpp v59, v59, v59 row_ror:8 row_mask:0xf bank_mask:0xf
    s_nop 0
    v_add_f32_dpp v58, v58, v58 row_ror:4 row_mask:0xf bank_mask:0xf
    v_add_f32_dpp v59, v59, v59 row_ror:4 row_mask:0xf bank_mask:0xf
    s_nop 0
    v_add_f32_dpp v58, v58, v58 row_ror:2 row_mask:0xf bank_mask:0xf
    v_add_f32_dpp v59, v59, v59 row_ror:2 row_mask:0xf bank_mask:0xf
    s_nop 0
    v_add_f32_dpp v58, v58, v58 row_ror:1 row_mask:0xf bank_mask:0xf
    v_add_f32_dpp v59, v59, v59 row_ror:1 row_mask:0xf bank_mask:0xf
    v_cvt_pk_f16_f32 v58, v58, v59
    v_mov_b32_e64 v59, v10
    s_mov_b32 exec_lo, 0x10001
    s_mov_b32 exec_hi, 0x10001
    buffer_store_dwordx2 v[58:59], v41, s[8:11], s51 offen sc1
    s_mov_b64 exec, -1
    s_branch L_g2b
.p2align 12
L_g2b:
    s_mov_b64 exec, 1
    s_barrier
    buffer_store_dword v10, v1, s[8:11], s57 offen sc1
    s_mov_b64 exec, -1
    s_cmp_lt_i32 s5, 0
    s_cbranch_scc1 L_w1late
L_w1back:
    s_add_u32 m0, s100, 32768
    s_nop 0
    buffer_load_dwordx4 v6, s[12:15], s101 offen offset:0 lds
    s_add_u32 m0, s100, 33792
    s_nop 0
    buffer_load_dwordx4 v7, s[12:15], s101 offen offset:0 lds
    s_add_u32 m0, s100, 146560
    s_nop 0
    buffer_load_dwordx4 v6, s[12:15], s101 offen offset:896 lds
    s_add_u32 m0, s100, 147584
    s_nop 0
    buffer_load_dwordx4 v7, s[12:15], s101 offen offset:896 lds
    s_add_u32 m0, s100, 49024
    s_nop 0
    buffer_load_dwordx4 v6, s[12:15], s101 offen offset:128 lds
    s_add_u32 m0, s100, 50048
    s_nop 0
    buffer_load_dwordx4 v7, s[12:15], s101 offen offset:128 lds
    s_add_u32 m0, s100, 130304
    s_nop 0
    buffer_load_dwordx4 v6, s[12:15], s101 offen offset:768 lds
    s_add_u32 m0, s100, 131328
    s_nop 0
    buffer_load_dwordx4 v7, s[12:15], s101 offen offset:768 lds
    s_add_u32 m0, s100, 65280
    s_nop 0
    buffer_load_dwordx4 v6, s[12:15], s101 offen offset:256 lds
    s_add_u32 m0, s100, 66304
    s_nop 0
    buffer_load_dwordx4 v7, s[12:15], s101 offen offset:256 lds
    s_add_u32 m0, s100, 114048
    s_nop 0
    buffer_load_dwordx4 v6, s[12:15], s101 offen offset:640 lds
    s_add_u32 m0, s100, 115072
    s_nop 0
    buffer_load_dwordx4 v7, s[12:15], s101 offen offset:640 lds
    s_mov_b64 exec, 0
    s_cmp_eq_u32 s20, 0
    s_cbranch_scc1 L_stub0
    s_cmp_eq_u32 s20, 1
    s_cbranch_scc1 L_stub1
    s_cmp_eq_u32 s20, 2
    s_cbranch_scc1 L_stub2
    s_cmp_eq_u32 s20, 3
    s_cbranch_scc1 L_stub3
L_ret:
    s_mov_b64 exec, -1
    buffer_load_dword v11, v9, s[8:11], s94 offen sc1
    s_waitcnt vmcnt(0)
    s_mov_b64 exec, 1
    buffer_store_dword v10, v1, s[8:11], s55 offen sc1
    s_mov_b64 exec, -1
    s_branch L_s1c
L_s1:
    s_add_u32 s35, s35, 1
    s_waitcnt vmcnt(0)
L_s1c:
    v_cmp_ne_u32 vcc, v10, v11
    s_cmp_gt_u32 s35, 1048576
    s_cbranch_scc1 L_s1ok
    s_cbranch_vccz L_s1ok
    s_and_b64 exec, exec, vcc
    buffer_load_dword v11, v9, s[8:11], s94 offen sc1
    s_branch L_s1
L_s1ok:
    s_mov_b64 exec, -1
    s_add_u32 s98, s93, 0
    s_add_u32 m0, s92, 0
    s_nop 0
    buffer_load_dwordx4 v2, s[8:11], s98 offen offset:0 sc1 lds
    buffer_load_dwordx4 v8, s[8:11], s98 offen offset:1024 sc1 lds
    s_add_u32 m0, s92, 2048
    s_nop 0
    buffer_load_dwordx4 v3, s[8:11], s98 offen offset:0 sc1 lds
    s_add_u32 m0, s92, 0
    s_nop 0
    buffer_load_dwordx4 v8, s[8:11], s98 offen offset:3072 sc1 lds
    s_add_u32 s98, s93, 8192
    s_add_u32 m0, s92, 16384
    s_nop 0
    buffer_load_dwordx4 v2, s[8:11], s98 offen offset:0 sc1 lds
    buffer_load_dwordx4 v8, s[8:11], s98 offen offset:1024 sc1 lds
    s_add_u32 m0, s92, 18432
    s_nop 0
    buffer_load_dwordx4 v3, s[8:11], s98 offen offset:0 sc1 lds
    s_add_u32 m0, s92, 16384
    s_nop 0
    buffer_load_dwordx4 v8, s[8:11], s98 offen offset:3072 sc1 lds
    s_barrier
    s_add_u32 m0, s100, 81536
    s_nop 0
    buffer_load_dwordx4 v6, s[12:15], s101 offen offset:384 lds
    s_add_u32 m0, s100, 82560
    s_nop 0
    buffer_load_dwordx4 v7, s[12:15], s101 offen offset:384 lds
    buffer_load_dword v11, v9, s[8:11], s94 offen offset:8 sc1
    s_cmp_lt_u32 s20, 2
    s_cbranch_scc1 L_wd_3
    v_perm_b32 v80, v98, v96, s52
    v_perm_b32 v81, v102, v100, s52
    v_perm_b32 v82, v106, v104, s52
    v_perm_b32 v83, v110, v108, s52
    v_perm_b32 v84, v98, v96, s53
    v_perm_b32 v85, v102, v100, s53
    v_perm_b32 v86, v106, v104, s53
    v_perm_b32 v87, v110, v108, s53
    v_perm_b32 v88, v99, v97, s52
    v_perm_b32 v89, v103, v101, s52
    v_perm_b32 v90, v107, v105, s52
    v_perm_b32 v91, v111, v109, s52
    v_perm_b32 v92, v99, v97, s53
    v_perm_b32 v93, v103, v101, s53
    v_perm_b32 v94, v107, v105, s53
    v_perm_b32 v95, v111, v109, s53
L_wd_3:
    buffer_store_dwordx4 v[80:83], v1, s[8:11], s36 offen offset:0 sc1
    buffer_store_dwordx4 v[84:87], v1, s[8:11], s36 offen offset:1024 sc1
    buffer_store_dwordx4 v[88:91], v1, s[8:11], s36 offen offset:2048 sc1
    buffer_store_dwordx4 v[92:95], v1, s[8:11], s36 offen offset:3072 sc1
    s_waitcnt vmcnt(11)
    s_barrier
    s_waitcnt vmcnt(4)
    v_cmp_ne_u32_e64 vcc, v10, v11
    s_nop 1
    s_cbranch_vccnz L_pb_slow
L_pb_ok:
    s_add_u32 s98, s93, 16384
    s_add_u32 m0, s92, 32768
    s_nop 0
    buffer_load_dwordx4 v2, s[8:11], s98 offen offset:0 sc1 lds
    buffer_load_dwordx4 v8, s[8:11], s98 offen offset:1024 sc1 lds
    s_add_u32 m0, s92, 34816
    s_nop 0
    buffer_load_dwordx4 v3, s[8:11], s98 offen offset:0 sc1 lds
    s_add_u32 m0, s92, 32768
    s_nop 0
    buffer_load_dwordx4 v8, s[8:11], s98 offen offset:3072 sc1 lds
    s_add_u32 s98, s93, 24576
    s_add_u32 m0, s92, 49152
    s_nop 0
    buffer_load_dwordx4 v2, s[8:11], s98 offen offset:0 sc1 lds
    buffer_load_dwordx4 v8, s[8:11], s98 offen offset:1024 sc1 lds
    buffer_load_dword v15, v14, s[8:11], s54 offen sc1
    s_barrier
    s_waitcnt vmcnt(7)
    s_mov_b64 exec, 1
    buffer_store_dword v10, v1, s[8:11], s95 offen sc1
    s_mov_b64 exec, -1
    s_add_u32 m0, s92, 51200
    s_nop 0
    buffer_load_dwordx4 v3, s[8:11], s98 offen offset:0 sc1 lds
    s_add_u32 m0, s92, 49152
    s_nop 0
    buffer_load_dwordx4 v8, s[8:11], s98 offen offset:3072 sc1 lds
    s_add_u32 m0, s100, 97792
    s_nop 0
    buffer_load_dwordx4 v6, s[12:15], s101 offen offset:512 lds
    s_add_u32 m0, s100, 98816
    s_nop 0
    buffer_load_dwordx4 v7, s[12:15], s101 offen offset:512 lds
    s_waitcnt vmcnt(5)
    v_cmp_ne_u32 vcc, v10, v15
    s_nop 1
    s_cbranch_vccnz L_pw_slow
L_pw_ok:
    s_add_u32 m0, s92, 65536
    s_add_u32 s98, s37, 1048576
    buffer_load_dwordx4 v1, s[8:11], s98 offen offset:0 sc1 lds
    buffer_load_dwordx4 v1, s[8:11], s98 offen offset:1024 sc1 lds
    buffer_load_dwordx4 v1, s[8:11], s98 offen offset:2048 sc1 lds
    buffer_load_dwordx4 v1, s[8:11], s98 offen offset:3072 sc1 lds
    s_add_u32 m0, s92, 114688
    s_add_u32 s98, s37, 1064960
    buffer_load_dwordx4 v1, s[8:11], s98 offen offset:0 sc1 lds
    s_barrier
    s_lshl4_add_u32 s28, s2, s20
    s_cmp_eq_u32 s28, 0
    s_mov_b32 s28, 6651776
    s_cselect_b32 s28, s28, 536870912
    s_mov_b64 exec, 1
    buffer_store_dword v10, off, s[8:11], s28
    s_mov_b64 exec, -1
    buffer_load_dwordx4 v1, s[8:11], s98 offen offset:1024 sc1 lds
    buffer_load_dwordx4 v1, s[8:11], s98 offen offset:2048 sc1 lds
    buffer_load_dwordx4 v1, s[8:11], s98 offen offset:3072 sc1 lds
    s_add_u32 m0, s92, 131072
    s_add_u32 s98, s37, 1081344
    buffer_load_dwordx4 v1, s[8:11], s98 offen offset:0 sc1 lds
    buffer_load_dwordx4 v1, s[8:11], s98 offen offset:1024 sc1 lds
    buffer_load_dwordx4 v1, s[8:11], s98 offen offset:2048 sc1 lds
    buffer_load_dwordx4 v1, s[8:11], s98 offen offset:3072 sc1 lds
    s_add_u32 m0, s92, 147456
    s_add_u32 s98, s37, 1097728
    buffer_load_dwordx4 v1, s[8:11], s98 offen offset:0 sc1 lds
    buffer_load_dwordx4 v1, s[8:11], s98 offen offset:1024 sc1 lds
    s_waitcnt vmcnt(16)
    s_waitcnt vmcnt(14)
    s_barrier
    buffer_load_dword v13, v12, s[8:11], s56 offen sc1
    buffer_load_dwordx4 v1, s[8:11], s98 offen offset:2048 sc1 lds
    buffer_load_dwordx4 v1, s[8:11], s98 offen offset:3072 sc1 lds
    s_add_u32 m0, s92, 0
    s_add_u32 s98, s37, 1114112
    buffer_load_dwordx4 v1, s[8:11], s98 offen offset:0 sc1 lds
    buffer_load_dwordx4 v1, s[8:11], s98 offen offset:1024 sc1 lds
    buffer_load_dwordx4 v1, s[8:11], s98 offen offset:2048 sc1 lds
    buffer_load_dwordx4 v1, s[8:11], s98 offen offset:3072 sc1 lds
    s_add_u32 m0, s92, 16384
    s_add_u32 s98, s37, 1130496
    buffer_load_dwordx4 v1, s[8:11], s98 offen offset:0 sc1 lds
    buffer_load_dwordx4 v1, s[8:11], s98 offen offset:1024 sc1 lds
    buffer_load_dwordx4 v1, s[8:11], s98 offen offset:2048 sc1 lds
    buffer_load_dwordx4 v1, s[8:11], s98 offen offset:3072 sc1 lds
    s_waitcnt vmcnt(10)
    v_cmp_ne_u32_e64 vcc, v10, v13
    s_nop 1
    s_cbranch_vccnz L_p2_slow
L_p2_ok:
    s_add_u32 s99, s97, 4718592
    buffer_load_dwordx4 v[128:131], v1, s[8:11], s99 offen offset:0 sc1
    buffer_load_dwordx4 v[132:135], v1, s[8:11], s99 offen offset:1024 sc1
    buffer_load_dwordx4 v[136:139], v1, s[8:11], s99 offen offset:2048 sc1
    buffer_load_dwordx4 v[140:143], v1, s[8:11], s99 offen offset:3072 sc1
    s_waitcnt vmcnt(12)
    s_barrier
    s_add_u32 m0, s92, 32768
    s_add_u32 s98, s37, 1146880
    buffer_load_dwordx4 v1, s[8:11], s98 offen offset:0 sc1 lds
    buffer_load_dwordx4 v1, s[8:11], s98 offen offset:1024 sc1 lds
    buffer_load_dwordx4 v1, s[8:11], s98 offen offset:2048 sc1 lds
    buffer_load_dwordx4 v1, s[8:11], s98 offen offset:3072 sc1 lds
    s_add_u32 m0, s92, 49152
    s_add_u32 s98, s37, 1163264
    buffer_load_dwordx4 v1, s[8:11], s98 offen offset:0 sc1 lds
    buffer_load_dwordx4 v1, s[8:11], s98 offen offset:1024 sc1 lds
    buffer_load_dwordx4 v1, s[8:11], s98 offen offset:2048 sc1 lds
    buffer_load_dwordx4 v1, s[8:11], s98 offen offset:3072 sc1 lds
    s_add_u32 m0, s92, 81920
    s_add_u32 s98, s37, 1179648
    buffer_load_dwordx4 v1, s[8:11], s98 offen offset:0 sc1 lds
    buffer_load_dwordx4 v1, s[8:11], s98 offen offset:1024 sc1 lds
    buffer_load_dwordx4 v1, s[8:11], s98 offen offset:2048 sc1 lds
    buffer_load_dwordx4 v1, s[8:11], s98 offen offset:3072 sc1 lds
    s_add_u32 m0, s92, 98304
    s_add_u32 s98, s37, 1196032
    buffer_load_dwordx4 v1, s[8:11], s98 offen offset:0 sc1 lds
    buffer_load_dwordx4 v1, s[8:11], s98 offen offset:1024 sc1 lds
    buffer_load_dwordx4 v1, s[8:11], s98 offen offset:2048 sc1 lds
    s_waitcnt vmcnt(23)
    s_waitcnt vmcnt(19)
    s_barrier
    buffer_load_dwordx4 v1, s[8:11], s98 offen offset:3072 sc1 lds
    s_add_u32 m0, s92, 65536
    s_add_u32 s98, s37, 1212416
    buffer_load_dwordx4 v1, s[8:11], s98 offen offset:0 sc1 lds
    buffer_load_dwordx4 v1, s[8:11], s98 offen offset:1024 sc1 lds
    buffer_load_dwordx4 v1, s[8:11], s98 offen offset:2048 sc1 lds
    buffer_load_dwordx4 v1, s[8:11], s98 offen offset:3072 sc1 lds
    s_add_u32 m0, s92, 114688
    s_add_u32 s98, s37, 1228800
    buffer_load_dwordx4 v1, s[8:11], s98 offen offset:0 sc1 lds
    buffer_load_dwordx4 v1, s[8:11], s98 offen offset:1024 sc1 lds
    buffer_load_dwordx4 v1, s[8:11], s98 offen offset:2048 sc1 lds
    buffer_load_dwordx4 v1, s[8:11], s98 offen offset:3072 sc1 lds
    s_add_u32 s99, s97, 4722688
    buffer_load_dwordx4 v[144:147], v1, s[8:11], s99 offen offset:0 sc1
    buffer_load_dwordx4 v[148:151], v1, s[8:11], s99 offen offset:1024 sc1
    buffer_load_dwordx4 v[152:155], v1, s[8:11], s99 offen offset:2048 sc1
    buffer_load_dwordx4 v[156:159], v1, s[8:11], s99 offen offset:3072 sc1
    s_add_u32 s99, s97, 4726784
    buffer_load_dwordx4 v[160:163], v1, s[8:11], s99 offen offset:0 sc1
    buffer_load_dwordx4 v[164:167], v1, s[8:11], s99 offen offset:1024 sc1
    s_waitcnt vmcnt(26)
    s_waitcnt vmcnt(22)
    s_barrier
    s_add_u32 m0, s92, 131072
    s_add_u32 s98, s37, 1245184
    buffer_load_dwordx4 v1, s[8:11], s98 offen offset:0 sc1 lds
    buffer_load_dwordx4 v1, s[8:11], s98 offen offset:1024 sc1 lds
    buffer_load_dwordx4 v1, s[8:11], s98 offen offset:2048 sc1 lds
    buffer_load_dwordx4 v1, s[8:11], s98 offen offset:3072 sc1 lds
    s_add_u32 m0, s92, 147456
    s_add_u32 s98, s37, 1261568
    buffer_load_dwordx4 v1, s[8:11], s98 offen offset:0 sc1 lds
    buffer_load_dwordx4 v1, s[8:11], s98 offen offset:1024 sc1 lds
    buffer_load_dwordx4 v1, s[8:11], s98 offen offset:2048 sc1 lds
    buffer_load_dwordx4 v1, s[8:11], s98 offen offset:3072 sc1 lds
    buffer_load_dwordx4 v[168:171], v1, s[8:11], s99 offen offset:2048 sc1
    buffer_load_dwordx4 v[172:175], v1, s[8:11], s99 offen offset:3072 sc1
    s_add_u32 s99, s97, 4730880
    buffer_load_dwordx4 v[176:179], v1, s[8:11], s99 offen offset:0 sc1
    buffer_load_dwordx4 v[180:183], v1, s[8:11], s99 offen offset:1024 sc1
    buffer_load_dwordx4 v[184:187], v1, s[8:11], s99 offen offset:2048 sc1
    s_mul_i32 s29, s20, 512
    s_add_u32 s29, s29, 6881280
    s_mul_i32 s28, s21, 8448
    s_add_u32 s28, s28, s29
    s_add_u32 s58, s6, s28
    s_addc_u32 s59, s7, 0
    s_mul_i32 s28, s31, 8448
    s_add_u32 s28, s28, s29
    s_add_u32 s60, s6, s28
    s_addc_u32 s61, s7, 0
    s_add_u32 s28, s21, s31
    s_sub_u32 s28, s28, s23
    s_lshl_b32 s29, s24, 5
    s_add_u32 s30, s28, s29
    s_mul_i32 s28, s25, 114688
    v_add_u32 v12, s28, v1
    s_xor_b32 s28, s25, 32
    s_mul_i32 s28, s28, 114688
    v_add_u32_e64 v13, s28, v1
    s_mul_i32 s28, s30, 114688
    v_add_u32 v14, s28, v1
    s_xor_b32 s28, s30, 32
    s_mul_i32 s28, s28, 114688
    v_add_u32_e64 v15, s28, v1
    s_mul_i32 s28, s32, 57344
    s_add_u32 s28, s28, 8388608
    s_add_u32 s56, s28, s92
    s_mul_i32 s29, s25, 114688
    s_add_u32 s28, s28, s29
    s_add_u32 s93, s28, 49152
    s_add_u32 s94, s28, 53248
    s_waitcnt vmcnt(31)
    s_waitcnt vmcnt(27)
    s_barrier
    s_add_u32 m0, s92, 0
    s_add_u32 s98, s96, 4849664
    buffer_load_dwordx4 v1, s[8:11], s98 offen offset:0 sc1 lds
    buffer_load_dwordx4 v1, s[8:11], s98 offen offset:1024 sc1 lds
    buffer_load_dwordx4 v1, s[8:11], s98 offen offset:2048 sc1 lds
    buffer_load_dwordx4 v1, s[8:11], s98 offen offset:3072 sc1 lds
    s_add_u32 m0, s92, 16384
    s_add_u32 s98, s96, 4866048
    buffer_load_dwordx4 v1, s[8:11], s98 offen offset:0 sc1 lds
    buffer_load_dwordx4 v1, s[8:11], s98 offen offset:1024 sc1 lds
    buffer_load_dwordx4 v1, s[8:11], s98 offen offset:2048 sc1 lds
    buffer_load_dwordx4 v1, s[8:11], s98 offen offset:3072 sc1 lds
    buffer_load_dwordx4 v[188:191], v1, s[8:11], s99 offen offset:3072 sc1
    s_add_u32 s99, s97, 4784128
    buffer_load_dwordx4 v[192:195], v1, s[8:11], s99 offen offset:0 sc1
    buffer_load_dwordx4 v[196:199], v1, s[8:11], s99 offen offset:1024 sc1
    buffer_load_dwordx4 v[200:203], v1, s[8:11], s99 offen offset:2048 sc1
    buffer_load_dwordx4 v[204:207], v1, s[8:11], s99 offen offset:3072 sc1
    s_add_u32 s99, s97, 4788224
    buffer_load_dwordx4 v[208:211], v1, s[8:11], s99 offen offset:0 sc1
    buffer_load_dwordx4 v[212:215], v1, s[8:11], s99 offen offset:1024 sc1
    s_waitcnt vmcnt(38)
    s_waitcnt vmcnt(34)
    s_barrier
    s_add_u32 m0, s92, 32768
    s_add_u32 s98, s96, 4882432
    buffer_load_dwordx4 v1, s[8:11], s98 offen offset:0 sc1 lds
    buffer_load_dwordx4 v1, s[8:11], s98 offen offset:1024 sc1 lds
    buffer_load_dwordx4 v1, s[8:11], s98 offen offset:2048 sc1 lds
    buffer_load_dwordx4 v1, s[8:11], s98 offen offset:3072 sc1 lds
    s_add_u32 m0, s92, 49152
    s_add_u32 s98, s96, 4898816
    buffer_load_dwordx4 v1, s[8:11], s98 offen offset:0 sc1 lds
    buffer_load_dwordx4 v1, s[8:11], s98 offen offset:1024 sc1 lds
    buffer_load_dwordx4 v1, s[8:11], s98 offen offset:2048 sc1 lds
    buffer_load_dwordx4 v1, s[8:11], s98 offen offset:3072 sc1 lds
    buffer_load_dwordx4 v[216:219], v1, s[8:11], s99 offen offset:2048 sc1
    buffer_load_dwordx4 v[220:223], v1, s[8:11], s99 offen offset:3072 sc1
    s_add_u32 s99, s97, 4792320
    buffer_load_dwordx4 v[224:227], v1, s[8:11], s99 offen offset:0 sc1
    buffer_load_dwordx4 v[228:231], v1, s[8:11], s99 offen offset:1024 sc1
    buffer_load_dwordx4 v[232:235], v1, s[8:11], s99 offen offset:2048 sc1
    s_xor_b32 s28, s20, 0
    s_lshl_b32 s28, s28, 2
    s_lshr_b32 s28, 0x9874, s28
    s_and_b32 s28, s28, 15
    s_lshl_b32 s28, s28, 14
    v_add_u32 v4, s28, v1
    s_xor_b32 s28, s20, 1
    s_lshl_b32 s28, s28, 2
    s_lshr_b32 s28, 0x9874, s28
    s_and_b32 s28, s28, 15
    s_lshl_b32 s28, s28, 14
    v_add_u32_e64 v5, s28, v1
    s_xor_b32 s28, s20, 2
    s_lshl_b32 s28, s28, 2
    s_lshr_b32 s28, 0x9874, s28
    s_and_b32 s28, s28, 15
    s_lshl_b32 s28, s28, 14
    v_add_u32_e64 v6, s28, v1
    s_xor_b32 s28, s20, 3
    s_lshl_b32 s28, s28, 2
    s_lshr_b32 s28, 0x9874, s28
    s_and_b32 s28, s28, 15
    s_lshl_b32 s28, s28, 14
    v_add_u32_e64 v7, s28, v1
    s_mul_i32 s28, s25, 8448
    s_add_u32 s28, s28, 6881280
    s_add_u32 s36, s6, s28
    s_addc_u32 s37, s7, 0
    s_lshl_b32 s28, s25, 10
    s_lshl_b32 s29, s33, 7
    s_add_u32 s28, s28, s29
    s_lshl_b32 s29, s32, 20
    s_add_u32 s34, s28, s29
    s_mov_b32 s16, s38
    s_and_b32 s17, s39, 0xffff
    s_mov_b32 s18, 0x200000
    s_mov_b32 s19, 0x20000
    v_lshrrev_b32 v9, 4, v0
    v_lshlrev_b32 v9, 18, v9
    v_and_b32_e64 v10, 15, v0
    v_lshl_add_u32 v9, v10, 3, v9
    v_add_u32 v10, 65536, v1
    s_waitcnt vmcnt(37)
    s_waitcnt vmcnt(33)
    s_barrier
    s_load_dwordx4 s[40:43], s[58:59], 0x0 glc
    s_load_dwordx4 s[44:47], s[58:59], 0x42000 glc
    s_load_dwordx4 s[48:51], s[60:61], 0x0 glc
    s_load_dwordx4 s[52:55], s[60:61], 0x42000 glc
    s_add_u32 m0, s92, 81920
    s_add_u32 s98, s96, 4915200
    buffer_load_dwordx4 v1, s[8:11], s98 offen offset:0 sc1 lds
    buffer_load_dwordx4 v1, s[8:11], s98 offen offset:1024 sc1 lds
    buffer_load_dwordx4 v1, s[8:11], s98 offen offset:2048 sc1 lds
    buffer_load_dwordx4 v1, s[8:11], s98 offen offset:3072 sc1 lds
    s_add_u32 m0, s92, 98304
    s_add_u32 s98, s96, 4931584
    buffer_load_dwordx4 v1, s[8:11], s98 offen offset:0 sc1 lds
    buffer_load_dwordx4 v1, s[8:11], s98 offen offset:1024 sc1 lds
    buffer_load_dwordx4 v1, s[8:11], s98 offen offset:2048 sc1 lds
    buffer_load_dwordx4 v1, s[8:11], s98 offen offset:3072 sc1 lds
    buffer_load_dwordx4 v[236:239], v1, s[8:11], s99 offen offset:3072 sc1
    s_add_u32 s99, s97, 4796416
    buffer_load_dwordx4 v[240:243], v1, s[8:11], s99 offen offset:0 sc1
    buffer_load_dwordx4 v[244:247], v1, s[8:11], s99 offen offset:1024 sc1
    buffer_load_dwordx4 v[248:251], v1, s[8:11], s99 offen offset:2048 sc1
    buffer_load_dwordx4 v[252:255], v1, s[8:11], s99 offen offset:3072 sc1
    s_waitcnt lgkmcnt(0)
    s_and_b64 s[40:41], s[40:41], s[42:43]
    s_and_b64 s[44:45], s[44:45], s[46:47]
    s_and_b64 s[48:49], s[48:49], s[50:51]
    s_and_b64 s[52:53], s[52:53], s[54:55]
    s_and_b64 s[40:41], s[40:41], s[44:45]
    s_and_b64 s[48:49], s[48:49], s[52:53]
    s_and_b64 s[40:41], s[40:41], s[48:49]
    s_and_b32 s40, s40, s41
    s_cbranch_scc0 L_g2_p0_slow
L_g2_p0_ok:
    s_add_u32 s99, s56, 0
    buffer_load_dwordx4 v[80:83], v12, s[8:11], s99 offen sc1
    buffer_load_dwordx4 v[84:87], v13, s[8:11], s99 offen sc1
    buffer_load_dwordx4 v[88:91], v14, s[8:11], s99 offen sc1
    buffer_load_dwordx4 v[92:95], v15, s[8:11], s99 offen sc1
    s_add_u32 s99, s56, 1024
    buffer_load_dwordx4 v[96:99], v12, s[8:11], s99 offen sc1
    buffer_load_dwordx4 v[100:103], v13, s[8:11], s99 offen sc1
    buffer_load_dwordx4 v[104:107], v14, s[8:11], s99 offen sc1
    buffer_load_dwordx4 v[108:111], v15, s[8:11], s99 offen sc1
    s_add_u32 s99, s56, 2048
    buffer_load_dwordx4 v[112:115], v12, s[8:11], s99 offen sc1
    buffer_load_dwordx4 v[116:119], v13, s[8:11], s99 offen sc1
    buffer_load_dwordx4 v[120:123], v14, s[8:11], s99 offen sc1
    buffer_load_dwordx4 v[124:127], v15, s[8:11], s99 offen sc1
    s_load_dwordx4 s[40:43], s[58:59], 0x80 glc
    s_load_dwordx4 s[44:47], s[58:59], 0x42080 glc
    s_load_dwordx4 s[48:51], s[60:61], 0x80 glc
    s_load_dwordx4 s[52:55], s[60:61], 0x42080 glc
    s_setprio 0
    s_waitcnt vmcnt(11)
    v_mfma_f32_16x16x32_bf16 v[16:19], v[80:83], v[128:131], 0
    v_mfma_f32_16x16x32_bf16 v[20:23], v[80:83], v[132:135], 0
    v_mfma_f32_16x16x32_bf16 v[24:27], v[80:83], v[136:139], 0
    v_mfma_f32_16x16x32_bf16 v[28:31], v[80:83], v[140:143], 0
    s_waitcnt vmcnt(10)
    v_mfma_f32_16x16x32_bf16 v[32:35], v[84:87], v[128:131], 0
    v_mfma_f32_16x16x32_bf16 v[36:39], v[84:87], v[132:135], 0
    v_mfma_f32_16x16x32_bf16 v[40:43], v[84:87], v[136:139], 0
    v_mfma_f32_16x16x32_bf16 v[44:47], v[84:87], v[140:143], 0
    s_waitcnt vmcnt(9)
    v_mfma_f32_16x16x32_bf16 v[48:51], v[88:91], v[128:131], 0
    v_mfma_f32_16x16x32_bf16 v[52:55], v[88:91], v[132:135], 0
    v_mfma_f32_16x16x32_bf16 v[56:59], v[88:91], v[136:139], 0
    v_mfma_f32_16x16x32_bf16 v[60:63], v[88:91], v[140:143], 0
    s_waitcnt vmcnt(8)
    v_mfma_f32_16x16x32_bf16 v[64:67], v[92:95], v[128:131], 0
    v_mfma_f32_16x16x32_bf16 v[68:71], v[92:95], v[132:135], 0
    v_mfma_f32_16x16x32_bf16 v[72:75], v[92:95], v[136:139], 0
    v_mfma_f32_16x16x32_bf16 v[76:79], v[92:95], v[140:143], 0
    s_waitcnt vmcnt(7)
    s_add_u32 s99, s56, 3072
    buffer_load_dwordx4 v[80:83], v12, s[8:11], s99 offen sc1
    v_mfma_f32_16x16x32_bf16 v[16:19], v[96:99], v[144:147], v[16:19]
    v_mfma_f32_16x16x32_bf16 v[20:23], v[96:99], v[148:151], v[20:23]
    buffer_load_dwordx4 v[84:87], v13, s[8:11], s99 offen sc1
    v_mfma_f32_16x16x32_bf16 v[24:27], v[96:99], v[152:155], v[24:27]
    v_mfma_f32_16x16x32_bf16 v[28:31], v[96:99], v[156:159], v[28:31]
    s_waitcnt vmcnt(8)
    buffer_load_dwordx4 v[88:91], v14, s[8:11], s99 offen sc1
    v_mfma_f32_16x16x32_bf16 v[32:35], v[100:103], v[144:147], v[32:35]
    v_mfma_f32_16x16x32_bf16 v[36:39], v[100:103], v[148:151], v[36:39]
    buffer_load_dwordx4 v[92:95], v15, s[8:11], s99 offen sc1
    v_mfma_f32_16x16x32_bf16 v[40:43], v[100:103], v[152:155], v[40:43]
    v_mfma_f32_16x16x32_bf16 v[44:47], v[100:103], v[156:159], v[44:47]
    s_waitcnt vmcnt(9)
    s_waitcnt lgkmcnt(0)
    s_and_b64 s[40:41], s[40:41], s[42:43]
    s_and_b64 s[44:45], s[44:45], s[46:47]
    s_and_b64 s[48:49], s[48:49], s[50:51]
    s_and_b64 s[52:53], s[52:53], s[54:55]
    s_and_b64 s[40:41], s[40:41], s[44:45]
    s_and_b64 s[48:49], s[48:49], s[52:53]
    s_and_b64 s[40:41], s[40:41], s[48:49]
    s_and_b32 s40, s40, s41
    s_cbranch_scc0 L_g2_p1_slow
L_g2_p1_ok:
    s_add_u32 s99, s56, 16384
    buffer_load_dwordx4 v[128:131], v12, s[8:11], s99 offen sc1
    v_mfma_f32_16x16x32_bf16 v[48:51], v[104:107], v[144:147], v[48:51]
    v_mfma_f32_16x16x32_bf16 v[52:55], v[104:107], v[148:151], v[52:55]
    buffer_load_dwordx4 v[132:135], v13, s[8:11], s99 offen sc1
    v_mfma_f32_16x16x32_bf16 v[56:59], v[104:107], v[152:155], v[56:59]
    v_mfma_f32_16x16x32_bf16 v[60:63], v[104:107], v[156:159], v[60:63]
    s_waitcnt vmcnt(10)
    buffer_load_dwordx4 v[136:139], v14, s[8:11], s99 offen sc1
    v_mfma_f32_16x16x32_bf16 v[64:67], v[108:111], v[144:147], v[64:67]
    v_mfma_f32_16x16x32_bf16 v[68:71], v[108:111], v[148:151], v[68:71]
    buffer_load_dwordx4 v[140:143], v15, s[8:11], s99 offen sc1
    v_mfma_f32_16x16x32_bf16 v[72:75], v[108:111], v[152:155], v[72:75]
    v_mfma_f32_16x16x32_bf16 v[76:79], v[108:111], v[156:159], v[76:79]
    s_barrier
    s_setprio 1
    s_waitcnt vmcnt(11)
    s_add_u32 s99, s56, 17408
    buffer_load_dwordx4 v[96:99], v12, s[8:11], s99 offen sc1
    v_mfma_f32_16x16x32_bf16 v[16:19], v[112:115], v[160:163], v[16:19]
    v_mfma_f32_16x16x32_bf16 v[20:23], v[112:115], v[164:167], v[20:23]
    buffer_load_dwordx4 v[100:103], v13, s[8:11], s99 offen sc1
    v_mfma_f32_16x16x32_bf16 v[24:27], v[112:115], v[168:171], v[24:27]
    v_mfma_f32_16x16x32_bf16 v[28:31], v[112:115], v[172:175], v[28:31]
    s_waitcnt vmcnt(12)
    buffer_load_dwordx4 v[104:107], v14, s[8:11], s99 offen sc1
    v_mfma_f32_16x16x32_bf16 v[32:35], v[116:119], v[160:163], v[32:35]
    v_mfma_f32_16x16x32_bf16 v[36:39], v[116:119], v[164:167], v[36:39]
    buffer_load_dwordx4 v[108:111], v15, s[8:11], s99 offen sc1
    v_mfma_f32_16x16x32_bf16 v[40:43], v[116:119], v[168:171], v[40:43]
    v_mfma_f32_16x16x32_bf16 v[44:47], v[116:119], v[172:175], v[44:47]
    s_waitcnt vmcnt(13)
    s_add_u32 s99, s56, 18432
    buffer_load_dwordx4 v[144:147], v12, s[8:11], s99 offen sc1
    v_mfma_f32_16x16x32_bf16 v[48:51], v[120:123], v[160:163], v[48:51]
    v_mfma_f32_16x16x32_bf16 v[52:55], v[120:123], v[164:167], v[52:55]
    buffer_load_dwordx4 v[148:151], v13, s[8:11], s99 offen sc1
    v_mfma_f32_16x16x32_bf16 v[56:59], v[120:123], v[168:171], v[56:59]
    v_mfma_f32_16x16x32_bf16 v[60:63], v[120:123], v[172:175], v[60:63]
    s_waitcnt vmcnt(14)
    buffer_load_dwordx4 v[152:155], v14, s[8:11], s99 offen sc1
    v_mfma_f32_16x16x32_bf16 v[64:67], v[124:127], v[160:163], v[64:67]
    v_mfma_f32_16x16x32_bf16 v[68:71], v[124:127], v[164:167], v[68:71]
    buffer_load_dwordx4 v[156:159], v15, s[8:11], s99 offen sc1
    v_mfma_f32_16x16x32_bf16 v[72:75], v[124:127], v[168:171], v[72:75]
    v_mfma_f32_16x16x32_bf16 v[76:79], v[124:127], v[172:175], v[76:79]
    s_waitcnt vmcnt(15)
    s_add_u32 s99, s56, 19456
    buffer_load_dwordx4 v[112:115], v12, s[8:11], s99 offen sc1
    v_mfma_f32_16x16x32_bf16 v[16:19], v[80:83], v[176:179], v[16:19]
    v_mfma_f32_16x16x32_bf16 v[20:23], v[80:83], v[180:183], v[20:23]
    buffer_load_dwordx4 v[116:119], v13, s[8:11], s99 offen sc1
    v_mfma_f32_16x16x32_bf16 v[24:27], v[80:83], v[184:187], v[24:27]
    v_mfma_f32_16x16x32_bf16 v[28:31], v[80:83], v[188:191], v[28:31]
    s_waitcnt vmcnt(16)
    buffer_load_dwordx4 v[120:123], v14, s[8:11], s99 offen sc1
    v_mfma_f32_16x16x32_bf16 v[32:35], v[84:87], v[176:179], v[32:35]
    v_mfma_f32_16x16x32_bf16 v[36:39], v[84:87], v[180:183], v[36:39]
    buffer_load_dwordx4 v[124:127], v15, s[8:11], s99 offen sc1
    v_mfma_f32_16x16x32_bf16 v[40:43], v[84:87], v[184:187], v[40:43]
    v_mfma_f32_16x16x32_bf16 v[44:47], v[84:87], v[188:191], v[44:47]
    s_waitcnt vmcnt(17)
    v_mfma_f32_16x16x32_bf16 v[48:51], v[88:91], v[176:179], v[48:51]
    v_mfma_f32_16x16x32_bf16 v[52:55], v[88:91], v[180:183], v[52:55]
    v_mfma_f32_16x16x32_bf16 v[56:59], v[88:91], v[184:187], v[56:59]
    v_mfma_f32_16x16x32_bf16 v[60:63], v[88:91], v[188:191], v[60:63]
    s_waitcnt vmcnt(16)
    v_mfma_f32_16x16x32_bf16 v[64:67], v[92:95], v[176:179], v[64:67]
    v_mfma_f32_16x16x32_bf16 v[68:71], v[92:95], v[180:183], v[68:71]
    v_mfma_f32_16x16x32_bf16 v[72:75], v[92:95], v[184:187], v[72:75]
    v_mfma_f32_16x16x32_bf16 v[76:79], v[92:95], v[188:191], v[76:79]
    s_waitcnt vmcnt(15)
    v_mfma_f32_16x16x32_bf16 v[16:19], v[128:131], v[192:195], v[16:19]
    v_mfma_f32_16x16x32_bf16 v[20:23], v[128:131], v[196:199], v[20:23]
    ds_read_b128 v[80:83], v10 offset:16384
    v_mfma_f32_16x16x32_bf16 v[24:27], v[128:131], v[200:203], v[24:27]
    v_mfma_f32_16x16x32_bf16 v[28:31], v[128:131], v[204:207], v[28:31]
    ds_read_b128 v[84:87], v10 offset:17408
    s_waitcnt vmcnt(14)
    v_mfma_f32_16x16x32_bf16 v[32:35], v[132:135], v[192:195], v[32:35]
    v_mfma_f32_16x16x32_bf16 v[36:39], v[132:135], v[196:199], v[36:39]
    ds_read_b128 v[88:91], v10 offset:18432
    v_mfma_f32_16x16x32_bf16 v[40:43], v[132:135], v[200:203], v[40:43]
    v_mfma_f32_16x16x32_bf16 v[44:47], v[132:135], v[204:207], v[44:47]
    ds_read_b128 v[92:95], v10 offset:19456
    s_waitcnt vmcnt(13)
    v_mfma_f32_16x16x32_bf16 v[48:51], v[136:139], v[192:195], v[48:51]
    v_mfma_f32_16x16x32_bf16 v[52:55], v[136:139], v[196:199], v[52:55]
    v_mfma_f32_16x16x32_bf16 v[56:59], v[136:139], v[200:203], v[56:59]
    v_mfma_f32_16x16x32_bf16 v[60:63], v[136:139], v[204:207], v[60:63]
    s_waitcnt vmcnt(12)
    v_mfma_f32_16x16x32_bf16 v[64:67], v[140:143], v[192:195], v[64:67]
    v_mfma_f32_16x16x32_bf16 v[68:71], v[140:143], v[196:199], v[68:71]
    v_mfma_f32_16x16x32_bf16 v[72:75], v[140:143], v[200:203], v[72:75]
    v_mfma_f32_16x16x32_bf16 v[76:79], v[140:143], v[204:207], v[76:79]
    s_waitcnt vmcnt(11)
    v_mfma_f32_16x16x32_bf16 v[16:19], v[96:99], v[208:211], v[16:19]
    v_mfma_f32_16x16x32_bf16 v[20:23], v[96:99], v[212:215], v[20:23]
L_stub0:
    s_cbranch_execz L_ret
    ds_read_b128 v[128:131], v10 offset:20480
    v_mfma_f32_16x16x32_bf16 v[24:27], v[96:99], v[216:219], v[24:27]
    v_mfma_f32_16x16x32_bf16 v[28:31], v[96:99], v[220:223], v[28:31]
    ds_read_b128 v[132:135], v10 offset:21504
    s_waitcnt vmcnt(10)
    v_mfma_f32_16x16x32_bf16 v[32:35], v[100:103], v[208:211], v[32:35]
    v_mfma_f32_16x16x32_bf16 v[36:39], v[100:103], v[212:215], v[36:39]
    ds_read_b128 v[136:139], v10 offset:22528
    v_mfma_f32_16x16x32_bf16 v[40:43], v[100:103], v[216:219], v[40:43]
    v_mfma_f32_16x16x32_bf16 v[44:47], v[100:103], v[220:223], v[44:47]
    ds_read_b128 v[140:143], v10 offset:23552
    s_waitcnt vmcnt(9)
    v_mfma_f32_16x16x32_bf16 v[48:51], v[104:107], v[208:211], v[48:51]
    v_mfma_f32_16x16x32_bf16 v[52:55], v[104:107], v[212:215], v[52:55]
    ds_read_b128 v[192:195], v10 offset:24576
    v_mfma_f32_16x16x32_bf16 v[56:59], v[104:107], v[216:219], v[56:59]
    v_mfma_f32_16x16x32_bf16 v[60:63], v[104:107], v[220:223], v[60:63]
    ds_read_b128 v[196:199], v10 offset:25600
    s_waitcnt vmcnt(8)
    v_mfma_f32_16x16x32_bf16 v[64:67], v[108:111], v[208:211], v[64:67]
    v_mfma_f32_16x16x32_bf16 v[68:71], v[108:111], v[212:215], v[68:71]
    ds_read_b128 v[200:203], v10 offset:26624
    v_mfma_f32_16x16x32_bf16 v[72:75], v[108:111], v[216:219], v[72:75]
    v_mfma_f32_16x16x32_bf16 v[76:79], v[108:111], v[220:223], v[76:79]
    ds_read_b128 v[204:207], v10 offset:27648
    s_waitcnt vmcnt(7)
    v_mfma_f32_16x16x32_bf16 v[16:19], v[144:147], v[224:227], v[16:19]
    v_mfma_f32_16x16x32_bf16 v[20:23], v[144:147], v[228:231], v[20:23]
    ds_read_b128 v[96:99], v10 offset:28672
    v_mfma_f32_16x16x32_bf16 v[24:27], v[144:147], v[232:235], v[24:27]
    v_mfma_f32_16x16x32_bf16 v[28:31], v[144:147], v[236:239], v[28:31]
    ds_read_b128 v[100:103], v10 offset:29696
    s_waitcnt vmcnt(6)
    v_mfma_f32_16x16x32_bf16 v[32:35], v[148:151], v[224:227], v[32:35]
    v_mfma_f32_16x16x32_bf16 v[36:39], v[148:151], v[228:231], v[36:39]
    ds_read_b128 v[104:107], v10 offset:30720
    v_mfma_f32_16x16x32_bf16 v[40:43], v[148:151], v[232:235], v[40:43]
    v_mfma_f32_16x16x32_bf16 v[44:47], v[148:151], v[236:239], v[44:47]
    ds_read_b128 v[108:111], v10 offset:31744
    s_waitcnt vmcnt(5)
    v_mfma_f32_16x16x32_bf16 v[48:51], v[152:155], v[224:227], v[48:51]
    v_mfma_f32_16x16x32_bf16 v[52:55], v[152:155], v[228:231], v[52:55]
    ds_read_b128 v[208:211], v10 offset:32768
    v_mfma_f32_16x16x32_bf16 v[56:59], v[152:155], v[232:235], v[56:59]
    v_mfma_f32_16x16x32_bf16 v[60:63], v[152:155], v[236:239], v[60:63]
    ds_read_b128 v[212:215], v10 offset:33792
    s_waitcnt vmcnt(4)
    v_mfma_f32_16x16x32_bf16 v[64:67], v[156:159], v[224:227], v[64:67]
    v_mfma_f32_16x16x32_bf16 v[68:71], v[156:159], v[228:231], v[68:71]
    ds_read_b128 v[216:219], v10 offset:34816
    v_mfma_f32_16x16x32_bf16 v[72:75], v[156:159], v[232:235], v[72:75]
    v_mfma_f32_16x16x32_bf16 v[76:79], v[156:159], v[236:239], v[76:79]
    ds_read_b128 v[220:223], v10 offset:35840
    s_waitcnt vmcnt(2)
    v_mfma_f32_16x16x32_bf16 v[32:35], v[116:119], v[240:243], v[32:35]
    v_mfma_f32_16x16x32_bf16 v[36:39], v[116:119], v[244:247], v[36:39]
    ds_read_b128 v[144:147], v10 offset:36864
    v_mfma_f32_16x16x32_bf16 v[40:43], v[116:119], v[248:251], v[40:43]
    v_mfma_f32_16x16x32_bf16 v[44:47], v[116:119], v[252:255], v[44:47]
    ds_read_b128 v[148:151], v10 offset:37888
    s_waitcnt vmcnt(1)
    v_mfma_f32_16x16x32_bf16 v[48:51], v[120:123], v[240:243], v[48:51]
    v_mfma_f32_16x16x32_bf16 v[52:55], v[120:123], v[244:247], v[52:55]
    ds_read_b128 v[152:155], v10 offset:38912
    v_mfma_f32_16x16x32_bf16 v[56:59], v[120:123], v[248:251], v[56:59]
    v_mfma_f32_16x16x32_bf16 v[60:63], v[120:123], v[252:255], v[60:63]
    ds_read_b128 v[156:159], v10 offset:39936
    s_waitcnt vmcnt(0)
    v_mfma_f32_16x16x32_bf16 v[64:67], v[124:127], v[240:243], v[64:67]
    v_mfma_f32_16x16x32_bf16 v[68:71], v[124:127], v[244:247], v[68:71]
    ds_read_b128 v[224:227], v10 offset:40960
    v_mfma_f32_16x16x32_bf16 v[72:75], v[124:127], v[248:251], v[72:75]
    v_mfma_f32_16x16x32_bf16 v[76:79], v[124:127], v[252:255], v[76:79]
    ds_read_b128 v[228:231], v10 offset:41984
    v_mfma_f32_16x16x32_bf16 v[16:19], v[112:115], v[240:243], v[16:19]
    v_mfma_f32_16x16x32_bf16 v[20:23], v[112:115], v[244:247], v[20:23]
    ds_read_b128 v[232:235], v10 offset:43008
    v_mfma_f32_16x16x32_bf16 v[24:27], v[112:115], v[248:251], v[24:27]
    v_mfma_f32_16x16x32_bf16 v[28:31], v[112:115], v[252:255], v[28:31]
    ds_read_b128 v[236:239], v10 offset:44032
    s_load_dwordx4 s[40:43], s[36:37], 0x180 glc
    s_load_dwordx4 s[44:47], s[36:37], 0x380 glc
    s_load_dwordx4 s[48:51], s[36:37], 0x580 glc
    s_load_dwordx4 s[52:55], s[36:37], 0x780 glc
    ds_write_b128 v4, v[32:35] offset:4096
    ds_write_b128 v4, v[36:39] offset:5120
    ds_write_b128 v4, v[40:43] offset:6144
    ds_write_b128 v4, v[44:47] offset:7168
    ds_write_b128 v4, v[48:51] offset:8192
    ds_write_b128 v4, v[52:55] offset:9216
    ds_write_b128 v4, v[56:59] offset:10240
    ds_write_b128 v4, v[60:63] offset:11264
    ds_write_b128 v4, v[64:67] offset:12288
    ds_write_b128 v4, v[68:71] offset:13312
    ds_write_b128 v4, v[72:75] offset:14336
    ds_write_b128 v4, v[76:79] offset:15360
    ds_read_b128 v[112:115], v10 offset:45056
    ds_read_b128 v[116:119], v10 offset:46080
    ds_read_b128 v[120:123], v10 offset:47104
    ds_read_b128 v[124:127], v10 offset:48128
    s_waitcnt lgkmcnt(0)
    s_and_b64 s[40:41], s[40:41], s[42:43]
    s_and_b64 s[44:45], s[44:45], s[46:47]
    s_and_b64 s[48:49], s[48:49], s[50:51]
    s_and_b64 s[52:53], s[52:53], s[54:55]
    s_and_b64 s[40:41], s[40:41], s[44:45]
    s_and_b64 s[48:49], s[48:49], s[52:53]
    s_and_b64 s[40:41], s[40:41], s[48:49]
    s_and_b32 s40, s40, s41
    s_cbranch_scc0 L_g2_p3_slow
L_g2_p3_ok:
    buffer_load_dwordx4 v[160:163], v1, s[8:11], s93 offen offset:0 sc1
    buffer_load_dwordx4 v[164:167], v1, s[8:11], s93 offen offset:1024 sc1
    buffer_load_dwordx4 v[168:171], v1, s[8:11], s93 offen offset:2048 sc1
    buffer_load_dwordx4 v[172:175], v1, s[8:11], s93 offen offset:3072 sc1
    buffer_load_dwordx4 v[176:179], v1, s[8:11], s94 offen offset:0 sc1
    buffer_load_dwordx4 v[180:183], v1, s[8:11], s94 offen offset:1024 sc1
    buffer_load_dwordx4 v[184:187], v1, s[8:11], s94 offen offset:2048 sc1
    buffer_load_dwordx4 v[188:191], v1, s[8:11], s94 offen offset:3072 sc1
    s_waitcnt lgkmcnt(0)
    s_setprio 3
    s_barrier
    ds_read_b128 v[32:35], v5 offset:4096
    ds_read_b128 v[36:39], v5 offset:5120
    ds_read_b128 v[40:43], v5 offset:6144
    ds_read_b128 v[44:47], v5 offset:7168
    ds_read_b128 v[48:51], v6 offset:8192
    ds_read_b128 v[52:55], v6 offset:9216
    ds_read_b128 v[56:59], v6 offset:10240
    ds_read_b128 v[60:63], v6 offset:11264
    ds_read_b128 v[64:67], v7 offset:12288
    ds_read_b128 v[68:71], v7 offset:13312
    ds_read_b128 v[72:75], v7 offset:14336
    ds_read_b128 v[76:79], v7 offset:15360
    ds_read_b128 v[240:243], v4 offset:0
    ds_read_b128 v[244:247], v4 offset:1024
    ds_read_b128 v[248:251], v4 offset:2048
    ds_read_b128 v[252:255], v4 offset:3072
    s_waitcnt vmcnt(7)
    v_mfma_f32_16x16x32_bf16 v[16:19], v[160:163], v[80:83], v[16:19]
    v_mfma_f32_16x16x32_bf16 v[20:23], v[160:163], v[84:87], v[20:23]
    v_mfma_f32_16x16x32_bf16 v[24:27], v[160:163], v[88:91], v[24:27]
    v_mfma_f32_16x16x32_bf16 v[28:31], v[160:163], v[92:95], v[28:31]
    s_waitcnt vmcnt(6)
    v_mfma_f32_16x16x32_bf16 v[16:19], v[164:167], v[128:131], v[16:19]
    s_waitcnt lgkmcnt(8)
    v_add_f32 v32, v32, v48
    v_mfma_f32_16x16x32_bf16 v[20:23], v[164:167], v[132:135], v[20:23]
    v_add_f32 v33, v33, v49
    v_add_f32 v34, v34, v50
    v_mfma_f32_16x16x32_bf16 v[24:27], v[164:167], v[136:139], v[24:27]
    v_add_f32 v35, v35, v51
    v_add_f32 v36, v36, v52
    v_mfma_f32_16x16x32_bf16 v[28:31], v[164:167], v[140:143], v[28:31]
    v_add_f32 v37, v37, v53
    v_add_f32_e64 v38, v38, v54
    s_waitcnt vmcnt(5)
    v_mfma_f32_16x16x32_bf16 v[16:19], v[168:171], v[192:195], v[16:19]
    v_add_f32 v39, v39, v55
    v_add_f32 v40, v40, v56
    v_mfma_f32_16x16x32_bf16 v[20:23], v[168:171], v[196:199], v[20:23]
    v_add_f32 v41, v41, v57
    v_add_f32 v42, v42, v58
    v_mfma_f32_16x16x32_bf16 v[24:27], v[168:171], v[200:203], v[24:27]
    v_add_f32 v43, v43, v59
    v_add_f32 v44, v44, v60
    v_mfma_f32_16x16x32_bf16 v[28:31], v[168:171], v[204:207], v[28:31]
    v_add_f32 v45, v45, v61
    v_add_f32_e64 v46, v46, v62
    s_waitcnt vmcnt(4)
    v_mfma_f32_16x16x32_bf16 v[16:19], v[172:175], v[96:99], v[16:19]
    v_add_f32 v47, v47, v63
    s_waitcnt lgkmcnt(4)
    v_mfma_f32_16x16x32_bf16 v[20:23], v[172:175], v[100:103], v[20:23]
    v_add_f32 v32, v32, v64
    v_add_f32 v33, v33, v65
    v_mfma_f32_16x16x32_bf16 v[24:27], v[172:175], v[104:107], v[24:27]
    v_add_f32 v34, v34, v66
    v_add_f32 v35, v35, v67
    v_mfma_f32_16x16x32_bf16 v[28:31], v[172:175], v[108:111], v[28:31]
    v_add_f32 v36, v36, v68
    v_add_f32_e64 v37, v37, v69
    s_waitcnt vmcnt(3)
    v_mfma_f32_16x16x32_bf16 v[16:19], v[176:179], v[208:211], v[16:19]
    v_add_f32 v38, v38, v70
    v_add_f32 v39, v39, v71
    v_mfma_f32_16x16x32_bf16 v[20:23], v[176:179], v[212:215], v[20:23]
    v_add_f32 v40, v40, v72
    v_add_f32 v41, v41, v73
    v_mfma_f32_16x16x32_bf16 v[24:27], v[176:179], v[216:219], v[24:27]
    v_add_f32 v42, v42, v74
    v_add_f32 v43, v43, v75
    v_mfma_f32_16x16x32_bf16 v[28:31], v[176:179], v[220:223], v[28:31]
    v_add_f32 v44, v44, v76
    v_add_f32_e64 v45, v45, v77
    s_waitcnt vmcnt(2)
    v_mfma_f32_16x16x32_bf16 v[16:19], v[180:183], v[144:147], v[16:19]
    v_add_f32 v46, v46, v78
    v_add_f32 v47, v47, v79
    v_mfma_f32_16x16x32_bf16 v[20:23], v[180:183], v[148:151], v[20:23]
    s_waitcnt lgkmcnt(0)
    v_add_f32 v32, v32, v240
    v_mfma_f32_16x16x32_bf16 v[24:27], v[180:183], v[152:155], v[24:27]
    v_add_f32 v33, v33, v241
    v_add_f32 v34, v34, v242
    v_mfma_f32_16x16x32_bf16 v[28:31], v[180:183], v[156:159], v[28:31]
    v_add_f32 v35, v35, v243
    v_add_f32_e64 v36, v36, v244
    s_waitcnt vmcnt(1)
    v_mfma_f32_16x16x32_bf16 v[16:19], v[184:187], v[224:227], v[16:19]
    v_add_f32 v37, v37, v245
    v_add_f32 v38, v38, v246
    v_mfma_f32_16x16x32_bf16 v[20:23], v[184:187], v[228:231], v[20:23]
    v_add_f32 v39, v39, v247
    v_add_f32 v40, v40, v248
    v_mfma_f32_16x16x32_bf16 v[24:27], v[184:187], v[232:235], v[24:27]
    v_add_f32 v41, v41, v249
    v_add_f32 v42, v42, v250
    v_mfma_f32_16x16x32_bf16 v[28:31], v[184:187], v[236:239], v[28:31]
    v_add_f32 v43, v43, v251
    v_add_f32_e64 v44, v44, v252
    s_waitcnt vmcnt(0)
    v_mfma_f32_16x16x32_bf16 v[16:19], v[188:191], v[112:115], v[16:19]
    v_add_f32 v45, v45, v253
    v_add_f32 v46, v46, v254
    v_mfma_f32_16x16x32_bf16 v[20:23], v[188:191], v[116:119], v[20:23]
    v_add_f32_e64 v47, v47, v255
    v_mfma_f32_16x16x32_bf16 v[24:27], v[188:191], v[120:123], v[24:27]
    v_mfma_f32_16x16x32_bf16 v[28:31], v[188:191], v[124:127], v[28:31]
    s_nop 1
    v_add_f32 v16, v16, v32
    s_nop 1
    v_add_f32 v20, v20, v36
    s_nop 0
    v_add_f32 v24, v24, v40
    v_add_f32_e64 v28, v28, v44
    v_cvt_pk_bf16_f32 v64, v16, v20
    v_cvt_pk_bf16_f32 v65, v24, v28
    buffer_store_dwordx2 v[64:65], v9, s[16:19], s34 offen
    s_add_u32 s34, s34, 65536
    v_add_f32 v17, v17, v33
    v_add_f32 v21, v21, v37
    v_add_f32 v25, v25, v41
    v_add_f32 v29, v29, v45
    v_cvt_pk_bf16_f32 v66, v17, v21
    v_cvt_pk_bf16_f32 v67, v25, v29
    buffer_store_dwordx2 v[66:67], v9, s[16:19], s34 offen
    s_add_u32 s34, s34, 65536
    v_add_f32 v18, v18, v34
    v_add_f32 v22, v22, v38
    v_add_f32 v26, v26, v42
    v_add_f32 v30, v30, v46
    v_cvt_pk_bf16_f32 v68, v18, v22
    v_cvt_pk_bf16_f32 v69, v26, v30
    buffer_store_dwordx2 v[68:69], v9, s[16:19], s34 offen
    s_add_u32 s34, s34, 65536
    v_add_f32 v19, v19, v35
    v_add_f32 v23, v23, v39
    v_add_f32 v27, v27, v43
    v_add_f32 v31, v31, v47
    v_cvt_pk_bf16_f32 v70, v19, v23
    v_cvt_pk_bf16_f32 v71, v27, v31
    buffer_store_dwordx2 v[70:71], v9, s[16:19], s34 offen
    s_endpgm
L_w1late:
    s_waitcnt vmcnt(1)
    ds_read_b64_tr_b16 v[64:65], v32 offset:0
    ds_read_b64_tr_b16 v[66:67], v32 offset:2048
    ds_read_b64_tr_b16 v[68:69], v32 offset:32
    ds_read_b64_tr_b16 v[70:71], v32 offset:2080
    ds_read_b64_tr_b16 v[72:73], v32 offset:64
    ds_read_b64_tr_b16 v[74:75], v32 offset:2112
    ds_read_b64_tr_b16 v[76:77], v32 offset:96
    ds_read_b64_tr_b16 v[78:79], v32 offset:2144
    s_waitcnt lgkmcnt(6)
    buffer_store_dwordx4 v[64:67], v1, s[8:11], s4 offen sc1
    s_add_u32 s4, s4, 32768
    s_waitcnt lgkmcnt(4)
    buffer_store_dwordx4 v[68:71], v1, s[8:11], s4 offen sc1
    s_add_u32 s4, s4, 32768
    s_waitcnt lgkmcnt(2)
    buffer_store_dwordx4 v[72:75], v1, s[8:11], s4 offen sc1
    s_add_u32 s4, s4, 32768
    s_waitcnt lgkmcnt(0)
    buffer_store_dwordx4 v[76:79], v1, s[8:11], s4 offen sc1
    s_branch L_w1back
L_pb_slow:
    buffer_load_dword v11, v9, s[8:11], s94 offen offset:8 sc1
    s_add_u32 s35, s35, 1
    s_waitcnt vmcnt(0)
    v_cmp_ne_u32 vcc, v10, v11
    s_cmp_gt_u32 s35, 1048576
    s_cbranch_scc1 L_pb_ok
    s_cbranch_vccnz L_pb_slow
    s_branch L_pb_ok
L_pw_slow:
    buffer_load_dword v15, v14, s[8:11], s54 offen sc1
    s_add_u32 s35, s35, 1
    s_waitcnt vmcnt(0)
    v_cmp_ne_u32 vcc, v10, v15
    s_cmp_gt_u32 s35, 1048576
    s_cbranch_scc1 L_pw_ok
    s_cbranch_vccnz L_pw_slow
    s_branch L_pw_ok
L_p2_slow:
    buffer_load_dword v13, v12, s[8:11], s56 offen sc1
    s_add_u32 s35, s35, 1
    s_waitcnt vmcnt(0)
    v_cmp_ne_u32 vcc, v10, v13
    s_cmp_gt_u32 s35, 1048576
    s_cbranch_scc1 L_p2_ok
    s_cbranch_vccnz L_p2_slow
    s_branch L_p2_ok
L_g2_p0_slow:
L_g2_p0_spin:
    s_load_dwordx4 s[40:43], s[58:59], 0x0 glc
    s_load_dwordx4 s[44:47], s[58:59], 0x42000 glc
    s_load_dwordx4 s[48:51], s[60:61], 0x0 glc
    s_load_dwordx4 s[52:55], s[60:61], 0x42000 glc
    s_add_u32 s35, s35, 1
    s_cmp_gt_u32 s35, 1048576
    s_cselect_b32 s57, 1, 0
    s_waitcnt lgkmcnt(0)
    s_and_b64 s[40:41], s[40:41], s[42:43]
    s_and_b64 s[44:45], s[44:45], s[46:47]
    s_and_b64 s[48:49], s[48:49], s[50:51]
    s_and_b64 s[52:53], s[52:53], s[54:55]
    s_and_b64 s[40:41], s[40:41], s[44:45]
    s_and_b64 s[48:49], s[48:49], s[52:53]
    s_and_b64 s[40:41], s[40:41], s[48:49]
    s_and_b32 s40, s40, s41
    s_or_b32 s40, s40, s57
    s_cbranch_scc0 L_g2_p0_spin
    s_branch L_g2_p0_ok
L_g2_p1_slow:
L_g2_p1_spin:
    s_load_dwordx4 s[40:43], s[58:59], 0x80 glc
    s_load_dwordx4 s[44:47], s[58:59], 0x42080 glc
    s_load_dwordx4 s[48:51], s[60:61], 0x80 glc
    s_load_dwordx4 s[52:55], s[60:61], 0x42080 glc
    s_add_u32 s35, s35, 1
    s_cmp_gt_u32 s35, 1048576
    s_cselect_b32 s57, 1, 0
    s_waitcnt lgkmcnt(0)
    s_and_b64 s[40:41], s[40:41], s[42:43]
    s_and_b64 s[44:45], s[44:45], s[46:47]
    s_and_b64 s[48:49], s[48:49], s[50:51]
    s_and_b64 s[52:53], s[52:53], s[54:55]
    s_and_b64 s[40:41], s[40:41], s[44:45]
    s_and_b64 s[48:49], s[48:49], s[52:53]
    s_and_b64 s[40:41], s[40:41], s[48:49]
    s_and_b32 s40, s40, s41
    s_or_b32 s40, s40, s57
    s_cbranch_scc0 L_g2_p1_spin
    s_branch L_g2_p1_ok
L_g2_p3_slow:
L_g2_p3_spin:
    s_load_dwordx4 s[40:43], s[36:37], 0x180 glc
    s_load_dwordx4 s[44:47], s[36:37], 0x380 glc
    s_load_dwordx4 s[48:51], s[36:37], 0x580 glc
    s_load_dwordx4 s[52:55], s[36:37], 0x780 glc
    s_add_u32 s35, s35, 1
    s_cmp_gt_u32 s35, 1048576
    s_cselect_b32 s57, 1, 0
    s_waitcnt lgkmcnt(0)
    s_and_b64 s[40:41], s[40:41], s[42:43]
    s_and_b64 s[44:45], s[44:45], s[46:47]
    s_and_b64 s[48:49], s[48:49], s[50:51]
    s_and_b64 s[52:53], s[52:53], s[54:55]
    s_and_b64 s[40:41], s[40:41], s[44:45]
    s_and_b64 s[48:49], s[48:49], s[52:53]
    s_and_b64 s[40:41], s[40:41], s[48:49]
    s_and_b32 s40, s40, s41
    s_or_b32 s40, s40, s57
    s_cbranch_scc0 L_g2_p3_spin
    s_branch L_g2_p3_ok
L_g1_p2_slow:
L_g1_p2_spin:
    s_load_dwordx4 s[40:43], s[60:61], 0x100 glc
    s_load_dwordx4 s[44:47], s[60:61], 0x300 glc
    s_load_dwordx4 s[48:51], s[60:61], 0x500 glc
    s_load_dwordx4 s[52:55], s[60:61], 0x700 glc
    s_add_u32 s35, s35, 1
    s_cmp_gt_u32 s35, 1048576
    s_cselect_b32 s57, 1, 0
    s_waitcnt lgkmcnt(0)
    s_and_b64 s[40:41], s[40:41], s[42:43]
    s_and_b64 s[44:45], s[44:45], s[46:47]
    s_and_b64 s[48:49], s[48:49], s[50:51]
    s_and_b64 s[52:53], s[52:53], s[54:55]
    s_and_b64 s[40:41], s[40:41], s[44:45]
    s_and_b64 s[48:49], s[48:49], s[52:53]
    s_and_b64 s[40:41], s[40:41], s[48:49]
    s_and_b32 s40, s40, s41
    s_or_b32 s40, s40, s57
    s_cbranch_scc0 L_g1_p2_spin
    s_branch L_g1_p2_ok
.p2align 12
L_g1:
L_zc:
    s_add_u32 s35, s35, 1
    s_waitcnt vmcnt(0)
    v_cmp_ne_u32 s[42:43], v55, v97
    v_cmp_ne_u32 s[44:45], v55, v89
    v_cmp_ne_u32 s[46:47], v55, v91
    v_cmp_ne_u32 s[48:49], v55, v93
    v_cmp_ne_u32 s[50:51], v55, v95
    s_cmp_gt_u32 s35, 1048576
    s_cbranch_scc1 L_zcok
    s_or_b64 s[42:43], s[42:43], s[44:45]
    s_or_b64 s[46:47], s[46:47], s[48:49]
    s_or_b64 s[42:43], s[42:43], s[50:51]
    s_or_b64 s[42:43], s[42:43], s[46:47]
    s_cbranch_scc0 L_zcok
    s_sleep 3
    buffer_load_dwordx2 v[96:97], v46, s[8:11], s16 offen sc1
    buffer_load_dwordx4 v[88:91], v47, s[8:11], s17 offen offset:0 sc1
    buffer_load_dwordx4 v[92:95], v47, s[8:11], s17 offen offset:256 sc1
    s_branch L_zc
L_zcok:
    v_mov_b32 v60, v96
    v_mov_b32 v61, v96
    s_nop 1
    v_permlane16_swap_b32 v60, v61
    v_perm_b32 v62, v61, v60, s40
    v_perm_b32 v63, v61, v60, s41
    v_cndmask_b32 v60, v62, v60, vcc
    v_cndmask_b32 v61, v63, v61, vcc
    v_pk_fma_f16 v60, v61, s92, v60
    ds_bpermute_b32 v120, v56, v60 offset:0
    ds_bpermute_b32 v121, v56, v60 offset:4
    ds_bpermute_b32 v122, v56, v60 offset:32
    ds_bpermute_b32 v123, v56, v60 offset:36
    v_mov_b32 v32, v88
    v_mov_b32 v33, v88
    v_mov_b32 v34, v88
    v_mov_b32 v35, v88
    v_mul_u32_u24 v40, v90, v10
    v_mov_b32 v36, v92
    v_mov_b32 v37, v92
    v_mov_b32 v38, v92
    v_mov_b32 v39, v92
    v_mul_u32_u24_e64 v41, v94, v10
    s_waitcnt lgkmcnt(0)
    v_mfma_f32_16x16x32_f16 v[32:35], v[120:123], v[240:243], v[32:35]
    v_mfma_f32_16x16x32_f16 v[36:39], v[120:123], v[244:247], v[36:39]
    s_lshr_b32 s28, s15, 2
    v_mov_b32 v68, s28
    v_mad_i32_i24 v68, v12, s14, v68
    s_lshr_b32 s28, s15, 6
    v_subrev_u32 v69, s28, v68
    v_sub_u32 v68, v68, v13
    v_sub_u32 v69, v69, v13
    v_cmp_eq_u32 s[44:45], 0, v68
    v_cmp_eq_u32 s[46:47], 4, v68
    v_cmp_eq_u32 s[48:49], 8, v68
    v_cmp_eq_u32 s[50:51], 12, v68
    v_cmp_eq_u32 s[52:53], 0, v69
    v_cmp_eq_u32 s[54:55], 4, v69
    v_cmp_eq_u32 s[4:5], 8, v69
    v_cmp_eq_u32 s[18:19], 12, v69
    v_cmp_eq_u32 s[38:39], 16, v68
    s_barrier
    ds_read_b128 v[128:131], v6 offset:0
    ds_read_b128 v[132:135], v6 offset:2048
    ds_read_b128 v[136:139], v7 offset:0
    ds_read_b128 v[140:143], v7 offset:2048
    ds_read_b128 v[192:195], v45 offset:49152
    ds_read_b128 v[196:199], v45 offset:51200
    ds_read_b128 v[200:203], v44 offset:49152
    ds_read_b128 v[204:207], v44 offset:51200
    ds_read_b128 v[144:147], v6 offset:16384
    ds_read_b128 v[148:151], v6 offset:18432
    ds_read_b128 v[152:155], v7 offset:16384
    ds_read_b128 v[156:159], v7 offset:18432
    ds_read_b128 v[208:211], v45 offset:32768
    ds_read_b128 v[212:215], v45 offset:34816
    ds_read_b128 v[216:219], v44 offset:32768
    ds_read_b128 v[220:223], v44 offset:34816
    ds_read_b128 v[160:163], v6 offset:32768
    ds_read_b128 v[164:167], v6 offset:34816
    ds_read_b128 v[168:171], v7 offset:32768
    ds_read_b128 v[172:175], v7 offset:34816
    ds_read_b128 v[224:227], v45 offset:16384
    ds_read_b128 v[228:231], v45 offset:18432
    ds_read_b128 v[232:235], v44 offset:16384
    ds_read_b128 v[236:239], v44 offset:18432
    s_waitcnt lgkmcnt(0)
    s_barrier
    ds_read_b64_tr_b16 v[88:89], v2 offset:0
    ds_read_b64_tr_b16 v[90:91], v2 offset:1024
    ds_read_b64_tr_b16 v[104:105], v2 offset:2048
    ds_read_b64_tr_b16 v[106:107], v2 offset:3072
    ds_read_b64_tr_b16 v[92:93], v3 offset:0
    ds_read_b64_tr_b16 v[94:95], v3 offset:1024
    ds_read_b64_tr_b16 v[108:109], v3 offset:2048
    ds_read_b64_tr_b16 v[110:111], v3 offset:3072
    ds_read_b64_tr_b16 v[96:97], v2 offset:4096
    ds_read_b64_tr_b16 v[98:99], v2 offset:5120
    ds_read_b64_tr_b16 v[184:185], v2 offset:6144
    ds_read_b64_tr_b16 v[186:187], v2 offset:7168
    s_waitcnt lgkmcnt(4)
    v_pk_fma_f16 v88, v104, s92, v88
    v_pk_fma_f16 v89, v105, s92, v89
    v_pk_fma_f16 v90, v106, s92, v90
    v_pk_fma_f16 v91, v107, s92, v91
    v_pk_fma_f16 v92, v108, s92, v92
    v_pk_fma_f16 v93, v109, s92, v93
    v_pk_fma_f16 v94, v110, s92, v94
    v_pk_fma_f16 v95, v111, s92, v95
    ds_read_b64_tr_b16 v[100:101], v3 offset:4096
    ds_read_b64_tr_b16 v[102:103], v3 offset:5120
    ds_read_b64_tr_b16 v[188:189], v3 offset:6144
    ds_read_b64_tr_b16 v[190:191], v3 offset:7168
    v_and_b32 v88, v11, v88
    v_and_b32 v89, v11, v89
    v_and_b32 v90, v11, v90
    v_and_b32_e64 v91, v11, v91
    s_nop 1
    v_mfma_f32_16x16x32_f16 v[56:59], v[88:91], v[240:243], v[32:35]
    v_mfma_f32_16x16x32_f16 v[60:63], v[88:91], v[244:247], v[36:39]
    v_mfma_f32_16x16x32_f16 v[64:67], v[92:95], v[240:243], v[32:35]
    v_mfma_f32_16x16x32_f16 v[68:71], v[92:95], v[244:247], v[36:39]
    s_waitcnt lgkmcnt(0)
    v_pk_fma_f16 v96, v184, s92, v96
    v_pk_fma_f16 v97, v185, s92, v97
    v_pk_fma_f16 v98, v186, s92, v98
    v_pk_fma_f16 v99, v187, s92, v99
    v_pk_fma_f16 v100, v188, s92, v100
    v_pk_fma_f16 v101, v189, s92, v101
    v_pk_fma_f16 v102, v190, s92, v102
    v_mfma_f32_16x16x32_bf16 v[56:59], v[248:251], v[128:131], v[56:59]
    ds_read_b64_tr_b16 v[88:89], v4 offset:0
    ds_read_b64_tr_b16 v[90:91], v4 offset:1024
    v_mfma_f32_16x16x32_bf16 v[64:67], v[252:255], v[128:131], v[64:67]
    ds_read_b64_tr_b16 v[104:105], v4 offset:2048
    ds_read_b64_tr_b16 v[106:107], v4 offset:3072
    v_pk_fma_f16 v103, v191, s92, v103
    v_mfma_f32_16x16x32_bf16 v[60:63], v[248:251], v[132:135], v[60:63]
    ds_read_b64_tr_b16 v[92:93], v5 offset:0
    ds_read_b64_tr_b16 v[94:95], v5 offset:1024
    v_mfma_f32_16x16x32_bf16 v[68:71], v[252:255], v[132:135], v[68:71]
    ds_read_b64_tr_b16 v[108:109], v5 offset:2048
    ds_read_b64_tr_b16 v[110:111], v5 offset:3072
    v_mfma_f32_16x16x32_f16 v[72:75], v[96:99], v[240:243], v[32:35]
    v_cvt_pk_bf16_f32 v128, v56, v57
    v_cvt_pk_bf16_f32 v129, v58, v59
    v_mfma_f32_16x16x32_f16 v[76:79], v[96:99], v[244:247], v[36:39]
    v_cvt_pk_bf16_f32 v130, v64, v65
    v_cvt_pk_bf16_f32 v131, v66, v67
    v_cvt_pk_bf16_f32 v132, v60, v61
    v_cvt_pk_bf16_f32 v133, v62, v63
    v_cvt_pk_bf16_f32 v134, v68, v69
    v_mfma_f32_16x16x32_f16 v[80:83], v[100:103], v[240:243], v[32:35]
    v_cvt_pk_bf16_f32 v135, v70, v71
    s_waitcnt lgkmcnt(0)
    v_mfma_f32_16x16x32_f16 v[84:87], v[100:103], v[244:247], v[36:39]
    v_pk_fma_f16 v88, v104, s93, v88
    v_pk_fma_f16 v89, v105, s93, v89
    v_pk_fma_f16 v90, v106, s93, v90
    v_pk_fma_f16 v91, v107, s93, v91
    v_pk_fma_f16 v92, v108, s93, v92
    v_mfma_f32_16x16x32_bf16 v[72:75], v[248:251], v[136:139], v[72:75]
    ds_read_b64_tr_b16 v[96:97], v4 offset:4096
    ds_read_b64_tr_b16 v[98:99], v4 offset:5120
    v_pk_fma_f16 v93, v109, s93, v93
    v_mfma_f32_16x16x32_bf16 v[80:83], v[252:255], v[136:139], v[80:83]
    ds_read_b64_tr_b16 v[184:185], v4 offset:6144
    ds_read_b64_tr_b16 v[186:187], v4 offset:7168
    v_pk_fma_f16 v94, v110, s93, v94
    v_mfma_f32_16x16x32_bf16 v[76:79], v[248:251], v[140:143], v[76:79]
    ds_read_b64_tr_b16 v[100:101], v5 offset:4096
    ds_read_b64_tr_b16 v[102:103], v5 offset:5120
    v_pk_fma_f16 v95, v111, s93, v95
    v_mfma_f32_16x16x32_bf16 v[84:87], v[252:255], v[140:143], v[84:87]
    ds_read_b64_tr_b16 v[188:189], v5 offset:6144
    ds_read_b64_tr_b16 v[190:191], v5 offset:7168
    v_mfma_f32_16x16x32_f16 v[56:59], v[88:91], v[16:19], v[32:35]
    v_cvt_pk_bf16_f32 v136, v72, v73
    v_cvt_pk_bf16_f32 v137, v74, v75
    v_mfma_f32_16x16x32_f16 v[60:63], v[88:91], v[20:23], v[36:39]
    v_cvt_pk_bf16_f32 v138, v80, v81
    v_cvt_pk_bf16_f32 v139, v82, v83
    v_cvt_pk_bf16_f32 v140, v76, v77
    v_mfma_f32_16x16x32_bf16 v[48:51], v[128:131], v[128:131], 0
    v_cvt_pk_bf16_f32 v141, v78, v79
    v_cvt_pk_bf16_f32 v142, v84, v85
    v_mfma_f32_16x16x32_f16 v[64:67], v[92:95], v[16:19], v[32:35]
    v_cvt_pk_bf16_f32 v143, v86, v87
    s_waitcnt lgkmcnt(0)
    v_mfma_f32_16x16x32_f16 v[68:71], v[92:95], v[20:23], v[36:39]
    v_pk_fma_f16 v96, v184, s93, v96
    v_pk_fma_f16 v97, v185, s93, v97
    v_pk_fma_f16 v98, v186, s93, v98
    v_mfma_f32_16x16x32_bf16 v[52:55], v[132:135], v[132:135], 0
    v_pk_fma_f16 v99, v187, s93, v99
    v_pk_fma_f16 v100, v188, s93, v100
    v_mfma_f32_16x16x32_bf16 v[56:59], v[24:27], v[192:195], v[56:59]
    s_barrier
    ds_read_b64_tr_b16 v[88:89], v2 offset:16384
    ds_read_b64_tr_b16 v[90:91], v2 offset:17408
    v_pk_fma_f16 v101, v189, s93, v101
    v_mfma_f32_16x16x32_bf16 v[64:67], v[28:31], v[192:195], v[64:67]
    ds_read_b64_tr_b16 v[104:105], v2 offset:18432
    ds_read_b64_tr_b16 v[106:107], v2 offset:19456
    v_pk_fma_f16 v102, v190, s93, v102
    v_mfma_f32_16x16x32_bf16 v[60:63], v[24:27], v[196:199], v[60:63]
    ds_read_b64_tr_b16 v[92:93], v3 offset:16384
    ds_read_b64_tr_b16 v[94:95], v3 offset:17408
    v_pk_fma_f16 v103, v191, s93, v103
    v_mfma_f32_16x16x32_bf16 v[68:71], v[28:31], v[196:199], v[68:71]
    ds_read_b64_tr_b16 v[108:109], v3 offset:18432
    ds_read_b64_tr_b16 v[110:111], v3 offset:19456
    v_mul_u32_u24 v42, v192, v10
    v_mul_u32_u24 v43, v196, v10
    v_mfma_f32_16x16x32_f16 v[72:75], v[96:99], v[16:19], v[32:35]
    v_add_f32_e64 v56, v56, v40
    v_cvt_pk_bf16_f32 v192, v56, v57
    v_mfma_f32_16x16x32_f16 v[76:79], v[96:99], v[20:23], v[36:39]
    v_cvt_pk_bf16_f32 v193, v58, v59
    v_cvt_pk_bf16_f32 v194, v64, v65
    v_cvt_pk_bf16_f32 v195, v66, v67
    v_mfma_f32_16x16x32_bf16 v[48:51], v[136:139], v[136:139], v[48:51]
    v_add_f32_e64 v60, v60, v41
    v_cvt_pk_bf16_f32 v196, v60, v61
    v_cvt_pk_bf16_f32 v197, v62, v63
    v_mfma_f32_16x16x32_f16 v[80:83], v[100:103], v[16:19], v[32:35]
    v_cvt_pk_bf16_f32 v198, v68, v69
    v_cvt_pk_bf16_f32 v199, v70, v71
    v_mfma_f32_16x16x32_f16 v[84:87], v[100:103], v[20:23], v[36:39]
    s_waitcnt lgkmcnt(0)
    v_pk_fma_f16 v88, v104, s92, v88
    v_pk_fma_f16 v89, v105, s92, v89
    v_mfma_f32_16x16x32_bf16 v[52:55], v[140:143], v[140:143], v[52:55]
    v_pk_fma_f16 v90, v106, s92, v90
    v_pk_fma_f16 v91, v107, s92, v91
    v_pk_fma_f16 v92, v108, s92, v92
    v_mfma_f32_16x16x32_bf16 v[72:75], v[24:27], v[200:203], v[72:75]
    ds_read_b64_tr_b16 v[96:97], v2 offset:20480
    ds_read_b64_tr_b16 v[98:99], v2 offset:21504
    v_pk_fma_f16 v93, v109, s92, v93
    v_mfma_f32_16x16x32_bf16 v[80:83], v[28:31], v[200:203], v[80:83]
    ds_read_b64_tr_b16 v[184:185], v2 offset:22528
    ds_read_b64_tr_b16 v[186:187], v2 offset:23552
    v_pk_fma_f16 v94, v110, s92, v94
    v_mfma_f32_16x16x32_bf16 v[76:79], v[24:27], v[204:207], v[76:79]
    ds_read_b64_tr_b16 v[100:101], v3 offset:20480
    ds_read_b64_tr_b16 v[102:103], v3 offset:21504
    v_pk_fma_f16 v95, v111, s92, v95
    v_mfma_f32_16x16x32_bf16 v[84:87], v[28:31], v[204:207], v[84:87]
    ds_read_b64_tr_b16 v[188:189], v3 offset:22528
    ds_read_b64_tr_b16 v[190:191], v3 offset:23552
    v_mul_u32_u24 v40, v200, v10
    v_mul_u32_u24_e64 v41, v204, v10
    v_mfma_f32_16x16x32_f16 v[56:59], v[88:91], v[240:243], v[32:35]
    v_add_f32_e64 v72, v72, v42
    v_cvt_pk_bf16_f32 v200, v72, v73
    v_mfma_f32_16x16x32_f16 v[60:63], v[88:91], v[244:247], v[36:39]
    v_cvt_pk_bf16_f32 v201, v74, v75
    v_cvt_pk_bf16_f32 v202, v80, v81
    v_cvt_pk_bf16_f32 v203, v82, v83
    v_mfma_f32_16x16x32_bf16 v[48:51], v[192:195], v[192:195], v[48:51]
    v_add_f32_e64 v76, v76, v43
    v_cvt_pk_bf16_f32 v204, v76, v77
    v_cvt_pk_bf16_f32 v205, v78, v79
    v_mfma_f32_16x16x32_f16 v[64:67], v[92:95], v[240:243], v[32:35]
    v_cvt_pk_bf16_f32 v206, v84, v85
    v_cvt_pk_bf16_f32 v207, v86, v87
    v_mfma_f32_16x16x32_f16 v[68:71], v[92:95], v[244:247], v[36:39]
    s_waitcnt lgkmcnt(0)
    v_pk_fma_f16 v96, v184, s92, v96
    v_pk_fma_f16 v97, v185, s92, v97
    v_mfma_f32_16x16x32_bf16 v[52:55], v[196:199], v[196:199], v[52:55]
    v_pk_fma_f16 v98, v186, s92, v98
    v_pk_fma_f16 v99, v187, s92, v99
    v_pk_fma_f16 v100, v188, s92, v100
    v_mfma_f32_16x16x32_bf16 v[56:59], v[248:251], v[144:147], v[56:59]
    ds_read_b64_tr_b16 v[88:89], v4 offset:16384
    ds_read_b64_tr_b16 v[90:91], v4 offset:17408
    v_pk_fma_f16 v101, v189, s92, v101
    v_mfma_f32_16x16x32_bf16 v[64:67], v[252:255], v[144:147], v[64:67]
    ds_read_b64_tr_b16 v[104:105], v4 offset:18432
    ds_read_b64_tr_b16 v[106:107], v4 offset:19456
    v_pk_fma_f16 v102, v190, s92, v102
    v_mfma_f32_16x16x32_bf16 v[60:63], v[248:251], v[148:151], v[60:63]
    ds_read_b64_tr_b16 v[92:93], v5 offset:16384
    ds_read_b64_tr_b16 v[94:95], v5 offset:17408
    v_pk_fma_f16 v103, v191, s92, v103
    v_mfma_f32_16x16x32_bf16 v[68:71], v[252:255], v[148:151], v[68:71]
    ds_read_b64_tr_b16 v[108:109], v5 offset:18432
    ds_read_b64_tr_b16 v[110:111], v5 offset:19456
    v_mfma_f32_16x16x32_f16 v[72:75], v[96:99], v[240:243], v[32:35]
    v_cvt_pk_bf16_f32 v144, v56, v57
    v_cvt_pk_bf16_f32 v145, v58, v59
    v_mfma_f32_16x16x32_f16 v[76:79], v[96:99], v[244:247], v[36:39]
    v_cvt_pk_bf16_f32 v146, v64, v65
    v_cvt_pk_bf16_f32 v147, v66, v67
    v_cvt_pk_bf16_f32 v148, v60, v61
    v_mfma_f32_16x16x32_bf16 v[48:51], v[200:203], v[200:203], v[48:51]
    v_cvt_pk_bf16_f32 v149, v62, v63
    v_cvt_pk_bf16_f32 v150, v68, v69
    v_mfma_f32_16x16x32_f16 v[80:83], v[100:103], v[240:243], v[32:35]
    v_cvt_pk_bf16_f32 v151, v70, v71
    s_waitcnt lgkmcnt(0)
    v_mfma_f32_16x16x32_f16 v[84:87], v[100:103], v[244:247], v[36:39]
    v_pk_fma_f16 v88, v104, s93, v88
    v_pk_fma_f16 v89, v105, s93, v89
    v_pk_fma_f16 v90, v106, s93, v90
    v_mfma_f32_16x16x32_bf16 v[52:55], v[204:207], v[204:207], v[52:55]
    v_pk_fma_f16 v91, v107, s93, v91
    v_pk_fma_f16 v92, v108, s93, v92
    v_mfma_f32_16x16x32_bf16 v[72:75], v[248:251], v[152:155], v[72:75]
    ds_read_b64_tr_b16 v[96:97], v4 offset:20480
    ds_read_b64_tr_b16 v[98:99], v4 offset:21504
    v_pk_fma_f16 v93, v109, s93, v93
    v_mfma_f32_16x16x32_bf16 v[80:83], v[252:255], v[152:155], v[80:83]
    ds_read_b64_tr_b16 v[184:185], v4 offset:22528
    ds_read_b64_tr_b16 v[186:187], v4 offset:23552
    v_pk_fma_f16 v94, v110, s93, v94
    v_mfma_f32_16x16x32_bf16 v[76:79], v[248:251], v[156:159], v[76:79]
    ds_read_b64_tr_b16 v[100:101], v5 offset:20480
    ds_read_b64_tr_b16 v[102:103], v5 offset:21504
    v_pk_fma_f16 v95, v111, s93, v95
    v_mfma_f32_16x16x32_bf16 v[84:87], v[252:255], v[156:159], v[84:87]
    ds_read_b64_tr_b16 v[188:189], v5 offset:22528
    ds_read_b64_tr_b16 v[190:191], v5 offset:23552
    v_mfma_f32_16x16x32_f16 v[56:59], v[88:91], v[16:19], v[32:35]
    v_cvt_pk_bf16_f32 v152, v72, v73
    v_cvt_pk_bf16_f32 v153, v74, v75
    v_mfma_f32_16x16x32_f16 v[60:63], v[88:91], v[20:23], v[36:39]
    v_cvt_pk_bf16_f32 v154, v80, v81
    v_cvt_pk_bf16_f32 v155, v82, v83
    v_cvt_pk_bf16_f32 v156, v76, v77
    v_mfma_f32_16x16x32_bf16 v[48:51], v[144:147], v[144:147], v[48:51]
    v_cvt_pk_bf16_f32 v157, v78, v79
    v_cvt_pk_bf16_f32 v158, v84, v85
    v_mfma_f32_16x16x32_f16 v[64:67], v[92:95], v[16:19], v[32:35]
    v_cvt_pk_bf16_f32 v159, v86, v87
    s_waitcnt lgkmcnt(0)
    v_mfma_f32_16x16x32_f16 v[68:71], v[92:95], v[20:23], v[36:39]
    v_pk_fma_f16 v96, v184, s93, v96
    v_pk_fma_f16 v97, v185, s93, v97
    v_pk_fma_f16 v98, v186, s93, v98
    v_mfma_f32_16x16x32_bf16 v[52:55], v[148:151], v[148:151], v[52:55]
    v_pk_fma_f16 v99, v187, s93, v99
    v_pk_fma_f16 v100, v188, s93, v100
    v_mfma_f32_16x16x32_bf16 v[56:59], v[24:27], v[208:211], v[56:59]
    s_barrier
    ds_read_b64_tr_b16 v[88:89], v2 offset:32768
    ds_read_b64_tr_b16 v[90:91], v2 offset:33792
    v_pk_fma_f16 v101, v189, s93, v101
    v_mfma_f32_16x16x32_bf16 v[64:67], v[28:31], v[208:211], v[64:67]
    ds_read_b64_tr_b16 v[104:105], v2 offset:34816
    ds_read_b64_tr_b16 v[106:107], v2 offset:35840
    v_pk_fma_f16 v102, v190, s93, v102
    v_mfma_f32_16x16x32_bf16 v[60:63], v[24:27], v[212:215], v[60:63]
    ds_read_b64_tr_b16 v[92:93], v3 offset:32768
    ds_read_b64_tr_b16 v[94:95], v3 offset:33792
    v_pk_fma_f16 v103, v191, s93, v103
    v_mfma_f32_16x16x32_bf16 v[68:71], v[28:31], v[212:215], v[68:71]
    ds_read_b64_tr_b16 v[108:109], v3 offset:34816
    ds_read_b64_tr_b16 v[110:111], v3 offset:35840
    v_mul_u32_u24 v42, v208, v10
    v_mul_u32_u24 v43, v212, v10
    v_mfma_f32_16x16x32_f16 v[72:75], v[96:99], v[16:19], v[32:35]
    v_add_f32_e64 v56, v56, v40
    v_cvt_pk_bf16_f32 v208, v56, v57
    v_mfma_f32_16x16x32_f16 v[76:79], v[96:99], v[20:23], v[36:39]
    v_cvt_pk_bf16_f32 v209, v58, v59
    v_cvt_pk_bf16_f32 v210, v64, v65
    v_cvt_pk_bf16_f32 v211, v66, v67
    v_mfma_f32_16x16x32_bf16 v[48:51], v[152:155], v[152:155], v[48:51]
    v_add_f32_e64 v60, v60, v41
    v_cvt_pk_bf16_f32 v212, v60, v61
    v_cvt_pk_bf16_f32 v213, v62, v63
    v_mfma_f32_16x16x32_f16 v[80:83], v[100:103], v[16:19], v[32:35]
    v_cvt_pk_bf16_f32 v214, v68, v69
    v_cvt_pk_bf16_f32 v215, v70, v71
    v_mfma_f32_16x16x32_f16 v[84:87], v[100:103], v[20:23], v[36:39]
    s_waitcnt lgkmcnt(0)
    v_pk_fma_f16 v88, v104, s92, v88
    v_pk_fma_f16 v89, v105, s92, v89
    v_mfma_f32_16x16x32_bf16 v[52:55], v[156:159], v[156:159], v[52:55]
    v_pk_fma_f16 v90, v106, s92, v90
    v_pk_fma_f16 v91, v107, s92, v91
    v_pk_fma_f16 v92, v108, s92, v92
    v_mfma_f32_16x16x32_bf16 v[72:75], v[24:27], v[216:219], v[72:75]
    ds_read_b64_tr_b16 v[96:97], v2 offset:36864
    ds_read_b64_tr_b16 v[98:99], v2 offset:37888
    v_pk_fma_f16 v93, v109, s92, v93
    v_mfma_f32_16x16x32_bf16 v[80:83], v[28:31], v[216:219], v[80:83]
    ds_read_b64_tr_b16 v[184:185], v2 offset:38912
    ds_read_b64_tr_b16 v[186:187], v2 offset:39936
    v_pk_fma_f16 v94, v110, s92, v94
    v_mfma_f32_16x16x32_bf16 v[76:79], v[24:27], v[220:223], v[76:79]
    ds_read_b64_tr_b16 v[100:101], v3 offset:36864
    ds_read_b64_tr_b16 v[102:103], v3 offset:37888
    v_pk_fma_f16 v95, v111, s92, v95
    v_mfma_f32_16x16x32_bf16 v[84:87], v[28:31], v[220:223], v[84:87]
    ds_read_b64_tr_b16 v[188:189], v3 offset:38912
    ds_read_b64_tr_b16 v[190:191], v3 offset:39936
    v_mul_u32_u24 v40, v216, v10
    v_mul_u32_u24_e64 v41, v220, v10
    v_mfma_f32_16x16x32_f16 v[56:59], v[88:91], v[240:243], v[32:35]
    v_add_f32_e64 v72, v72, v42
    v_cvt_pk_bf16_f32 v216, v72, v73
    v_mfma_f32_16x16x32_f16 v[60:63], v[88:91], v[244:247], v[36:39]
    v_cvt_pk_bf16_f32 v217, v74, v75
    v_cvt_pk_bf16_f32 v218, v80, v81
    v_cvt_pk_bf16_f32 v219, v82, v83
    v_mfma_f32_16x16x32_bf16 v[48:51], v[208:211], v[208:211], v[48:51]
    v_add_f32_e64 v76, v76, v43
    v_cvt_pk_bf16_f32 v220, v76, v77
    v_cvt_pk_bf16_f32 v221, v78, v79
    v_mfma_f32_16x16x32_f16 v[64:67], v[92:95], v[240:243], v[32:35]
    v_cvt_pk_bf16_f32 v222, v84, v85
    v_cvt_pk_bf16_f32 v223, v86, v87
    v_mfma_f32_16x16x32_f16 v[68:71], v[92:95], v[244:247], v[36:39]
    s_waitcnt lgkmcnt(0)
    v_pk_fma_f16 v96, v184, s92, v96
    v_pk_fma_f16 v97, v185, s92, v97
    v_mfma_f32_16x16x32_bf16 v[52:55], v[212:215], v[212:215], v[52:55]
    v_pk_fma_f16 v98, v186, s92, v98
    v_pk_fma_f16 v99, v187, s92, v99
    v_pk_fma_f16 v100, v188, s92, v100
    v_mfma_f32_16x16x32_bf16 v[56:59], v[248:251], v[160:163], v[56:59]
    ds_read_b64_tr_b16 v[88:89], v4 offset:32768
    ds_read_b64_tr_b16 v[90:91], v4 offset:33792
    v_pk_fma_f16 v101, v189, s92, v101
    v_mfma_f32_16x16x32_bf16 v[64:67], v[252:255], v[160:163], v[64:67]
    ds_read_b64_tr_b16 v[104:105], v4 offset:34816
    ds_read_b64_tr_b16 v[106:107], v4 offset:35840
    v_pk_fma_f16 v102, v190, s92, v102
    v_mfma_f32_16x16x32_bf16 v[60:63], v[248:251], v[164:167], v[60:63]
    ds_read_b64_tr_b16 v[92:93], v5 offset:32768
    ds_read_b64_tr_b16 v[94:95], v5 offset:33792
    v_pk_fma_f16 v103, v191, s92, v103
    v_mfma_f32_16x16x32_bf16 v[68:71], v[252:255], v[164:167], v[68:71]
    ds_read_b64_tr_b16 v[108:109], v5 offset:34816
    ds_read_b64_tr_b16 v[110:111], v5 offset:35840
    v_mfma_f32_16x16x32_f16 v[72:75], v[96:99], v[240:243], v[32:35]
    v_cvt_pk_bf16_f32 v160, v56, v57
    v_cvt_pk_bf16_f32 v161, v58, v59
    v_mfma_f32_16x16x32_f16 v[76:79], v[96:99], v[244:247], v[36:39]
    v_cvt_pk_bf16_f32 v162, v64, v65
    v_cvt_pk_bf16_f32 v163, v66, v67
    v_cvt_pk_bf16_f32 v164, v60, v61
    v_mfma_f32_16x16x32_bf16 v[48:51], v[216:219], v[216:219], v[48:51]
    v_cvt_pk_bf16_f32 v165, v62, v63
    v_cvt_pk_bf16_f32 v166, v68, v69
    v_mfma_f32_16x16x32_f16 v[80:83], v[100:103], v[240:243], v[32:35]
    v_cvt_pk_bf16_f32 v167, v70, v71
    s_waitcnt lgkmcnt(0)
    v_mfma_f32_16x16x32_f16 v[84:87], v[100:103], v[244:247], v[36:39]
    v_pk_fma_f16 v88, v104, s93, v88
    v_pk_fma_f16 v89, v105, s93, v89
    v_pk_fma_f16 v90, v106, s93, v90
    v_mfma_f32_16x16x32_bf16 v[52:55], v[220:223], v[220:223], v[52:55]
    v_pk_fma_f16 v91, v107, s93, v91
    v_pk_fma_f16 v92, v108, s93, v92
    v_mfma_f32_16x16x32_bf16 v[72:75], v[248:251], v[168:171], v[72:75]
    ds_read_b64_tr_b16 v[96:97], v4 offset:36864
    ds_read_b64_tr_b16 v[98:99], v4 offset:37888
    v_pk_fma_f16 v93, v109, s93, v93
    v_mfma_f32_16x16x32_bf16 v[80:83], v[252:255], v[168:171], v[80:83]
    ds_read_b64_tr_b16 v[184:185], v4 offset:38912
    ds_read_b64_tr_b16 v[186:187], v4 offset:39936
    v_pk_fma_f16 v94, v110, s93, v94
    v_mfma_f32_16x16x32_bf16 v[76:79], v[248:251], v[172:175], v[76:79]
    ds_read_b64_tr_b16 v[100:101], v5 offset:36864
    ds_read_b64_tr_b16 v[102:103], v5 offset:37888
    v_pk_fma_f16 v95, v111, s93, v95
    v_mfma_f32_16x16x32_bf16 v[84:87], v[252:255], v[172:175], v[84:87]
    ds_read_b64_tr_b16 v[188:189], v5 offset:38912
    ds_read_b64_tr_b16 v[190:191], v5 offset:39936
    v_mfma_f32_16x16x32_f16 v[56:59], v[88:91], v[16:19], v[32:35]
    v_cvt_pk_bf16_f32 v168, v72, v73
    v_cvt_pk_bf16_f32 v169, v74, v75
    v_mfma_f32_16x16x32_f16 v[60:63], v[88:91], v[20:23], v[36:39]
    v_cvt_pk_bf16_f32 v170, v80, v81
    v_cvt_pk_bf16_f32 v171, v82, v83
    v_cvt_pk_bf16_f32 v172, v76, v77
    v_mfma_f32_16x16x32_bf16 v[48:51], v[160:163], v[160:163], v[48:51]
    v_cvt_pk_bf16_f32 v173, v78, v79
    v_cvt_pk_bf16_f32 v174, v84, v85
    v_mfma_f32_16x16x32_f16 v[64:67], v[92:95], v[16:19], v[32:35]
    v_cvt_pk_bf16_f32 v175, v86, v87
    s_waitcnt lgkmcnt(0)
    v_mfma_f32_16x16x32_f16 v[68:71], v[92:95], v[20:23], v[36:39]
    v_pk_fma_f16 v96, v184, s93, v96
    v_pk_fma_f16 v97, v185, s93, v97
    v_pk_fma_f16 v98, v186, s93, v98
    v_mfma_f32_16x16x32_bf16 v[52:55], v[164:167], v[164:167], v[52:55]
    v_pk_fma_f16 v99, v187, s93, v99
    v_pk_fma_f16 v100, v188, s93, v100
    v_mfma_f32_16x16x32_bf16 v[56:59], v[24:27], v[224:227], v[56:59]
    s_barrier
    ds_read_b64_tr_b16 v[88:89], v2 offset:49152
    ds_read_b64_tr_b16 v[90:91], v2 offset:50176
    v_pk_fma_f16 v101, v189, s93, v101
    v_mfma_f32_16x16x32_bf16 v[64:67], v[28:31], v[224:227], v[64:67]
    ds_read_b64_tr_b16 v[104:105], v2 offset:51200
    ds_read_b64_tr_b16 v[106:107], v2 offset:52224
    v_pk_fma_f16 v102, v190, s93, v102
    v_mfma_f32_16x16x32_bf16 v[60:63], v[24:27], v[228:231], v[60:63]
    ds_read_b64_tr_b16 v[92:93], v3 offset:49152
    ds_read_b64_tr_b16 v[94:95], v3 offset:50176
    v_pk_fma_f16 v103, v191, s93, v103
    v_mfma_f32_16x16x32_bf16 v[68:71], v[28:31], v[228:231], v[68:71]
    ds_read_b64_tr_b16 v[108:109], v3 offset:51200
    ds_read_b64_tr_b16 v[110:111], v3 offset:52224
    v_mul_u32_u24 v42, v224, v10
    v_mul_u32_u24 v43, v228, v10
    v_mfma_f32_16x16x32_f16 v[72:75], v[96:99], v[16:19], v[32:35]
    ds_read_b128 v[112:115], v6 offset:49152
    ds_read_b128 v[116:119], v6 offset:51200
    v_add_f32_e64 v56, v56, v40
    v_cvt_pk_bf16_f32 v224, v56, v57
    v_mfma_f32_16x16x32_f16 v[76:79], v[96:99], v[20:23], v[36:39]
    v_cvt_pk_bf16_f32 v225, v58, v59
    v_cvt_pk_bf16_f32 v226, v64, v65
    v_cvt_pk_bf16_f32 v227, v66, v67
    v_mfma_f32_16x16x32_bf16 v[48:51], v[168:171], v[168:171], v[48:51]
    v_add_f32_e64 v60, v60, v41
    v_cvt_pk_bf16_f32 v228, v60, v61
    v_cvt_pk_bf16_f32 v229, v62, v63
    v_mfma_f32_16x16x32_f16 v[80:83], v[100:103], v[16:19], v[32:35]
    v_cvt_pk_bf16_f32 v230, v68, v69
    v_cvt_pk_bf16_f32 v231, v70, v71
    v_mfma_f32_16x16x32_f16 v[84:87], v[100:103], v[20:23], v[36:39]
    s_waitcnt lgkmcnt(2)
    v_pk_fma_f16 v88, v104, s92, v88
    v_pk_fma_f16 v89, v105, s92, v89
    v_mfma_f32_16x16x32_bf16 v[52:55], v[172:175], v[172:175], v[52:55]
    v_pk_fma_f16 v90, v106, s92, v90
    v_pk_fma_f16 v91, v107, s92, v91
    v_pk_fma_f16 v92, v108, s92, v92
    v_mfma_f32_16x16x32_bf16 v[72:75], v[24:27], v[232:235], v[72:75]
    ds_read_b64_tr_b16 v[96:97], v2 offset:53248
    ds_read_b64_tr_b16 v[98:99], v2 offset:54272
    v_pk_fma_f16 v93, v109, s92, v93
    v_mfma_f32_16x16x32_bf16 v[80:83], v[28:31], v[232:235], v[80:83]
    ds_read_b64_tr_b16 v[184:185], v2 offset:55296
    ds_read_b64_tr_b16 v[186:187], v2 offset:56320
    v_pk_fma_f16 v94, v110, s92, v94
L_stub1:
    s_cbranch_execz L_ret
    v_mfma_f32_16x16x32_bf16 v[76:79], v[24:27], v[236:239], v[76:79]
    ds_read_b64_tr_b16 v[100:101], v3 offset:53248
    ds_read_b64_tr_b16 v[102:103], v3 offset:54272
    v_pk_fma_f16 v95, v111, s92, v95
    v_mfma_f32_16x16x32_bf16 v[84:87], v[28:31], v[236:239], v[84:87]
    ds_read_b64_tr_b16 v[188:189], v3 offset:55296
    ds_read_b64_tr_b16 v[190:191], v3 offset:56320
    v_mul_u32_u24 v40, v232, v10
    v_mul_u32_u24 v41, v236, v10
    v_mfma_f32_16x16x32_f16 v[56:59], v[88:91], v[240:243], v[32:35]
    ds_read_b128 v[120:123], v7 offset:49152
    ds_read_b128 v[124:127], v7 offset:51200
    v_add_f32_e64 v72, v72, v42
    v_cvt_pk_bf16_f32 v232, v72, v73
    v_mfma_f32_16x16x32_f16 v[60:63], v[88:91], v[244:247], v[36:39]
    v_cvt_pk_bf16_f32 v233, v74, v75
    v_cvt_pk_bf16_f32 v234, v80, v81
    v_cvt_pk_bf16_f32 v235, v82, v83
    v_mfma_f32_16x16x32_bf16 v[48:51], v[224:227], v[224:227], v[48:51]
    v_add_f32_e64 v76, v76, v43
    v_cvt_pk_bf16_f32 v236, v76, v77
    v_cvt_pk_bf16_f32 v237, v78, v79
    v_mfma_f32_16x16x32_f16 v[64:67], v[92:95], v[240:243], v[32:35]
    v_cvt_pk_bf16_f32 v238, v84, v85
    v_cvt_pk_bf16_f32 v239, v86, v87
    v_mfma_f32_16x16x32_f16 v[68:71], v[92:95], v[244:247], v[36:39]
    s_waitcnt lgkmcnt(2)
    v_pk_fma_f16 v96, v184, s92, v96
    v_pk_fma_f16 v97, v185, s92, v97
    v_mfma_f32_16x16x32_bf16 v[52:55], v[228:231], v[228:231], v[52:55]
    v_pk_fma_f16 v98, v186, s92, v98
    v_pk_fma_f16 v99, v187, s92, v99
    v_pk_fma_f16 v100, v188, s92, v100
    v_mfma_f32_16x16x32_bf16 v[56:59], v[248:251], v[112:115], v[56:59]
    ds_read_b64_tr_b16 v[88:89], v4 offset:49152
    ds_read_b64_tr_b16 v[90:91], v4 offset:50176
    v_pk_fma_f16 v101, v189, s92, v101
    v_mfma_f32_16x16x32_bf16 v[64:67], v[252:255], v[112:115], v[64:67]
    ds_read_b64_tr_b16 v[104:105], v4 offset:51200
    ds_read_b64_tr_b16 v[106:107], v4 offset:52224
    v_pk_fma_f16 v102, v190, s92, v102
    v_mfma_f32_16x16x32_bf16 v[60:63], v[248:251], v[116:119], v[60:63]
    ds_read_b64_tr_b16 v[92:93], v5 offset:49152
    ds_read_b64_tr_b16 v[94:95], v5 offset:50176
    v_pk_fma_f16 v103, v191, s92, v103
    v_mfma_f32_16x16x32_bf16 v[68:71], v[252:255], v[116:119], v[68:71]
    ds_read_b64_tr_b16 v[108:109], v5 offset:51200
    ds_read_b64_tr_b16 v[110:111], v5 offset:52224
    v_mfma_f32_16x16x32_f16 v[72:75], v[96:99], v[240:243], v[32:35]
    ds_read_b128 v[112:115], v45 offset:0
    ds_read_b128 v[116:119], v45 offset:2048
    v_cvt_pk_bf16_f32 v176, v56, v57
    v_cvt_pk_bf16_f32 v177, v58, v59
    v_mfma_f32_16x16x32_f16 v[76:79], v[96:99], v[244:247], v[36:39]
    v_cvt_pk_bf16_f32 v178, v64, v65
    v_cvt_pk_bf16_f32 v179, v66, v67
    v_cvt_pk_bf16_f32 v180, v60, v61
    v_mfma_f32_16x16x32_bf16 v[48:51], v[232:235], v[232:235], v[48:51]
    v_cvt_pk_bf16_f32 v181, v62, v63
    v_cvt_pk_bf16_f32 v182, v68, v69
    v_mfma_f32_16x16x32_f16 v[80:83], v[100:103], v[240:243], v[32:35]
    v_cvt_pk_bf16_f32 v183, v70, v71
    s_waitcnt lgkmcnt(2)
    v_mfma_f32_16x16x32_f16 v[84:87], v[100:103], v[244:247], v[36:39]
    v_pk_fma_f16 v88, v104, s93, v88
    v_pk_fma_f16 v89, v105, s93, v89
    v_pk_fma_f16 v90, v106, s93, v90
    v_mfma_f32_16x16x32_bf16 v[52:55], v[236:239], v[236:239], v[52:55]
    v_pk_fma_f16 v91, v107, s93, v91
    v_pk_fma_f16 v92, v108, s93, v92
    v_mfma_f32_16x16x32_bf16 v[72:75], v[248:251], v[120:123], v[72:75]
    ds_read_b64_tr_b16 v[96:97], v4 offset:53248
    ds_read_b64_tr_b16 v[98:99], v4 offset:54272
    v_pk_fma_f16 v93, v109, s93, v93
    v_mfma_f32_16x16x32_bf16 v[80:83], v[252:255], v[120:123], v[80:83]
    ds_read_b64_tr_b16 v[240:241], v4 offset:55296
    ds_read_b64_tr_b16 v[242:243], v4 offset:56320
    v_pk_fma_f16 v94, v110, s93, v94
    v_mfma_f32_16x16x32_bf16 v[76:79], v[248:251], v[124:127], v[76:79]
    ds_read_b64_tr_b16 v[100:101], v5 offset:53248
    ds_read_b64_tr_b16 v[102:103], v5 offset:54272
    v_pk_fma_f16 v95, v111, s93, v95
    v_mfma_f32_16x16x32_bf16 v[84:87], v[252:255], v[124:127], v[84:87]
    ds_read_b64_tr_b16 v[244:245], v5 offset:55296
    ds_read_b64_tr_b16 v[246:247], v5 offset:56320
    v_mfma_f32_16x16x32_f16 v[56:59], v[88:91], v[16:19], v[32:35]
    ds_read_b128 v[120:123], v44 offset:0
    ds_read_b128 v[124:127], v44 offset:2048
    v_cvt_pk_bf16_f32 v184, v72, v73
    v_cvt_pk_bf16_f32 v185, v74, v75
    v_mfma_f32_16x16x32_f16 v[60:63], v[88:91], v[20:23], v[36:39]
    v_cvt_pk_bf16_f32 v186, v80, v81
    v_cvt_pk_bf16_f32 v187, v82, v83
    v_cvt_pk_bf16_f32 v188, v76, v77
    v_mfma_f32_16x16x32_bf16 v[48:51], v[176:179], v[176:179], v[48:51]
    v_cvt_pk_bf16_f32 v189, v78, v79
    v_cvt_pk_bf16_f32 v190, v84, v85
    v_mfma_f32_16x16x32_f16 v[64:67], v[92:95], v[16:19], v[32:35]
    v_cvt_pk_bf16_f32 v191, v86, v87
    s_waitcnt lgkmcnt(2)
    v_mfma_f32_16x16x32_f16 v[68:71], v[92:95], v[20:23], v[36:39]
    v_pk_fma_f16 v96, v240, s93, v96
    v_pk_fma_f16 v97, v241, s93, v97
    v_pk_fma_f16 v98, v242, s93, v98
    v_mfma_f32_16x16x32_bf16 v[52:55], v[180:183], v[180:183], v[52:55]
    v_pk_fma_f16 v99, v243, s93, v99
    v_pk_fma_f16 v100, v244, s93, v100
    v_mfma_f32_16x16x32_bf16 v[56:59], v[24:27], v[112:115], v[56:59]
    v_pk_fma_f16 v101, v245, s93, v101
    v_mfma_f32_16x16x32_bf16 v[64:67], v[28:31], v[112:115], v[64:67]
    v_pk_fma_f16 v102, v246, s93, v102
    v_mfma_f32_16x16x32_bf16 v[60:63], v[24:27], v[116:119], v[60:63]
    v_pk_fma_f16 v103, v247, s93, v103
    v_mfma_f32_16x16x32_bf16 v[68:71], v[28:31], v[116:119], v[68:71]
    v_mul_u32_u24 v42, v112, v10
    v_mul_u32_u24_e64 v43, v116, v10
    v_mfma_f32_16x16x32_f16 v[72:75], v[96:99], v[16:19], v[32:35]
    v_add_f32_e64 v56, v56, v40
    v_mfma_f32_16x16x32_f16 v[76:79], v[96:99], v[20:23], v[36:39]
    v_cvt_pk_bf16_f32 v240, v56, v57
    v_cvt_pk_bf16_f32 v241, v58, v59
    v_mfma_f32_16x16x32_bf16 v[48:51], v[184:187], v[184:187], v[48:51]
    v_cvt_pk_bf16_f32 v242, v64, v65
    v_mfma_f32_16x16x32_f16 v[80:83], v[100:103], v[16:19], v[32:35]
    v_cvt_pk_bf16_f32 v243, v66, v67
    v_add_f32_e64 v60, v60, v41
    v_mfma_f32_16x16x32_f16 v[84:87], v[100:103], v[20:23], v[36:39]
    v_cvt_pk_bf16_f32 v244, v60, v61
    v_mfma_f32_16x16x32_bf16 v[52:55], v[188:191], v[188:191], v[52:55]
    v_cvt_pk_bf16_f32 v245, v62, v63
    v_cvt_pk_bf16_f32 v246, v68, v69
    s_waitcnt lgkmcnt(0)
    v_mfma_f32_16x16x32_bf16 v[72:75], v[24:27], v[120:123], v[72:75]
    s_barrier
    ds_read_b128 v[88:91], v14 offset:0
    ds_read_b128 v[92:95], v14 offset:1024
    v_mfma_f32_16x16x32_bf16 v[80:83], v[28:31], v[120:123], v[80:83]
    ds_read_b128 v[104:107], v14 offset:2048
    ds_read_b128 v[108:111], v14 offset:3072
    v_cvt_pk_bf16_f32 v247, v70, v71
    v_mfma_f32_16x16x32_bf16 v[76:79], v[24:27], v[124:127], v[76:79]
    ds_read_b128 v[112:115], v14 offset:4096
    ds_read_b128 v[116:119], v14 offset:5120
    v_mfma_f32_16x16x32_bf16 v[84:87], v[28:31], v[124:127], v[84:87]
    s_cmp_eq_u32 s32, 0
    s_cselect_b64 s[40:41], -1, 0
    s_waitcnt lgkmcnt(4)
    v_mfma_f32_16x16x32_bf16 v[56:59], v[88:91], v[128:131], 0
    ds_read_b128 v[96:99], v14 offset:6144
    v_cndmask_b32 v6, v36, v32, s[40:41]
    v_mfma_f32_16x16x32_bf16 v[60:63], v[88:91], v[132:135], 0
    v_add_f32 v72, v72, v42
    v_mfma_f32_16x16x32_bf16 v[68:71], v[92:95], v[132:135], 0
    ds_read_b128 v[100:103], v14 offset:7168
    v_add_f32_e64 v76, v76, v43
    v_mfma_f32_16x16x32_bf16 v[64:67], v[92:95], v[128:131], 0
    v_mfma_f32_16x16x32_bf16 v[48:51], v[240:243], v[240:243], v[48:51]
    s_waitcnt lgkmcnt(4)
    v_mfma_f32_16x16x32_bf16 v[56:59], v[104:107], v[136:139], v[56:59]
    ds_read_b128 v[120:123], v14 offset:8192
    v_mfma_f32_16x16x32_bf16 v[52:55], v[244:247], v[244:247], v[52:55]
    v_mfma_f32_16x16x32_bf16 v[60:63], v[104:107], v[140:143], v[60:63]
    v_cmp_gt_u32 vcc, 1, v0
    v_mfma_f32_16x16x32_bf16 v[68:71], v[108:111], v[140:143], v[68:71]
    ds_read_b128 v[124:127], v14 offset:9216
    v_lshlrev_b32_e64 v10, 11, v0
    v_mfma_f32_16x16x32_bf16 v[64:67], v[108:111], v[136:139], v[64:67]
    v_cvt_pk_bf16_f32 v248, v72, v73
    s_waitcnt lgkmcnt(4)
    v_mfma_f32_16x16x32_bf16 v[56:59], v[112:115], v[144:147], v[56:59]
    ds_read_b128 v[44:47], v14 offset:10240
    v_cvt_pk_bf16_f32 v249, v74, v75
    v_cvt_pk_bf16_f32 v250, v80, v81
    v_mfma_f32_16x16x32_bf16 v[60:63], v[112:115], v[148:151], v[60:63]
    ds_read_b128 v[32:35], v14 offset:11264
    v_cvt_pk_bf16_f32 v251, v82, v83
    v_mfma_f32_16x16x32_bf16 v[68:71], v[116:119], v[148:151], v[68:71]
    ds_read_b128 v[36:39], v14 offset:12288
    v_cvt_pk_bf16_f32 v252, v76, v77
    v_mfma_f32_16x16x32_bf16 v[64:67], v[116:119], v[144:147], v[64:67]
    ds_read_b128 v[40:43], v14 offset:13312
    v_cvt_pk_bf16_f32 v253, v78, v79
    s_waitcnt lgkmcnt(6)
    v_mfma_f32_16x16x32_bf16 v[56:59], v[96:99], v[152:155], v[56:59]
    ds_read_b128 v[88:91], v14 offset:14336
    v_cvt_pk_bf16_f32 v254, v84, v85
    v_mfma_f32_16x16x32_bf16 v[60:63], v[96:99], v[156:159], v[60:63]
    ds_read_b128 v[92:95], v14 offset:15360
    v_cvt_pk_bf16_f32 v255, v86, v87
    v_mfma_f32_16x16x32_bf16 v[68:71], v[100:103], v[156:159], v[68:71]
    ds_read_b128 v[104:107], v14 offset:49152
    v_mov_b32 v7, 536870912
    v_mfma_f32_16x16x32_bf16 v[64:67], v[100:103], v[152:155], v[64:67]
    ds_read_b128 v[108:111], v14 offset:50176
    s_nop 0
    s_waitcnt lgkmcnt(6)
    v_mfma_f32_16x16x32_bf16 v[56:59], v[120:123], v[160:163], v[56:59]
    ds_read_b128 v[112:115], v14 offset:51200
    v_mfma_f32_16x16x32_bf16 v[48:51], v[248:251], v[248:251], v[48:51]
    v_mfma_f32_16x16x32_bf16 v[60:63], v[120:123], v[164:167], v[60:63]
    v_mfma_f32_16x16x32_bf16 v[52:55], v[252:255], v[252:255], v[52:55]
    v_mfma_f32_16x16x32_bf16 v[68:71], v[124:127], v[164:167], v[68:71]
    ds_read_b128 v[116:119], v14 offset:52224
    v_cndmask_b32_e64 v7, v7, v10, vcc
    v_mfma_f32_16x16x32_bf16 v[64:67], v[124:127], v[160:163], v[64:67]
    v_mov_b32_e64 v10, 1
    v_mfma_f32_16x16x32_bf16 v[56:59], v[44:47], v[168:171], v[56:59]
    ds_read_b128 v[96:99], v14 offset:53248
    v_and_b32_e64 v2, 1, v0
    v_mfma_f32_16x16x32_bf16 v[60:63], v[44:47], v[172:175], v[60:63]
    v_and_b32_e64 v3, 2, v0
    v_mfma_f32_16x16x32_bf16 v[68:71], v[32:35], v[172:175], v[68:71]
    ds_read_b128 v[100:103], v14 offset:54272
    v_cmp_eq_u32 s[40:41], 1, v2
    v_mfma_f32_16x16x32_bf16 v[64:67], v[32:35], v[168:171], v[64:67]
    v_cmp_eq_u32 s[42:43], 2, v3
    s_waitcnt lgkmcnt(6)
    v_mfma_f32_16x16x32_bf16 v[56:59], v[36:39], v[176:179], v[56:59]
    ds_read_b128 v[120:123], v14 offset:55296
    v_lshrrev_b32 v4, 2, v12
    v_lshl_add_u32 v4, v4, 4, v12
    v_mfma_f32_16x16x32_bf16 v[60:63], v[36:39], v[180:183], v[60:63]
    v_lshlrev_b32_e64 v4, 2, v4
    v_mfma_f32_16x16x32_bf16 v[68:71], v[40:43], v[180:183], v[68:71]
    ds_read_b128 v[124:127], v14 offset:56320
    v_cndmask_b32 v48, v48, v49, s[40:41]
    v_mfma_f32_16x16x32_bf16 v[64:67], v[40:43], v[176:179], v[64:67]
    v_cndmask_b32 v50, v50, v51, s[40:41]
    v_mfma_f32_16x16x32_bf16 v[56:59], v[88:91], v[184:187], v[56:59]
    ds_read_b128 v[44:47], v14 offset:57344
    v_cndmask_b32 v48, v48, v50, s[42:43]
    v_mfma_f32_16x16x32_bf16 v[60:63], v[88:91], v[188:191], v[60:63]
    ds_bpermute_b32 v8, v4, v48
    v_mfma_f32_16x16x32_bf16 v[68:71], v[92:95], v[188:191], v[68:71]
    ds_read_b128 v[32:35], v14 offset:58368
    v_cndmask_b32 v52, v52, v53, s[40:41]
    v_mfma_f32_16x16x32_bf16 v[64:67], v[92:95], v[184:187], v[64:67]
    v_cndmask_b32 v54, v54, v55, s[40:41]
    s_waitcnt lgkmcnt(7)
    v_mfma_f32_16x16x32_bf16 v[56:59], v[104:107], v[192:195], v[56:59]
    ds_read_b128 v[36:39], v14 offset:59392
    v_cndmask_b32 v52, v52, v54, s[42:43]
    v_mfma_f32_16x16x32_bf16 v[60:63], v[104:107], v[196:199], v[60:63]
    ds_bpermute_b32 v9, v4, v52
    v_mfma_f32_16x16x32_bf16 v[68:71], v[108:111], v[196:199], v[68:71]
    ds_read_b128 v[40:43], v14 offset:60416
    v_lshrrev_b32 v11, 1, v13
    v_mfma_f32_16x16x32_bf16 v[64:67], v[108:111], v[192:195], v[64:67]
    v_lshlrev_b32_e64 v11, 8, v11
    v_mfma_f32_16x16x32_bf16 v[56:59], v[112:115], v[200:203], v[56:59]
    ds_read_b128 v[88:91], v14 offset:61440
    v_lshl_add_u32 v11, v12, 4, v11
    v_mfma_f32_16x16x32_bf16 v[60:63], v[112:115], v[204:207], v[60:63]
    v_and_b32_e64 v2, 1, v13
    v_mfma_f32_16x16x32_bf16 v[68:71], v[116:119], v[204:207], v[68:71]
    ds_read_b128 v[92:95], v14 offset:62464
    v_mul_u32_u24 v2, 57344, v2
    v_mfma_f32_16x16x32_bf16 v[64:67], v[116:119], v[200:203], v[64:67]
    v_add_u32 v11, v11, v2
    s_waitcnt lgkmcnt(8)
    v_mfma_f32_16x16x32_bf16 v[56:59], v[96:99], v[208:211], v[56:59]
    ds_read_b128 v[104:107], v14 offset:63488
    v_mov_b32 v2, 0x3727c5ac
    v_mfma_f32_16x16x32_bf16 v[60:63], v[96:99], v[212:215], v[60:63]
    s_waitcnt lgkmcnt(4)
    v_fmamk_f32 v4, v8, 0x3b000000, v2
    v_mfma_f32_16x16x32_bf16 v[68:71], v[100:103], v[212:215], v[68:71]
    ds_read_b128 v[108:111], v14 offset:64512
    v_fmamk_f32 v5, v9, 0x3b000000, v2
    v_mfma_f32_16x16x32_bf16 v[64:67], v[100:103], v[208:211], v[64:67]
    v_mfma_f32_16x16x32_bf16 v[56:59], v[120:123], v[216:219], v[56:59]
    ds_read_b128 v[112:115], v15 offset:0
    v_rsq_f32 v2, v4
    v_mfma_f32_16x16x32_bf16 v[60:63], v[120:123], v[220:223], v[60:63]
    v_mfma_f32_16x16x32_bf16 v[68:71], v[124:127], v[220:223], v[68:71]
    ds_read_b128 v[116:119], v15 offset:1024
    v_rsq_f32_e64 v3, v5
    v_mfma_f32_16x16x32_bf16 v[64:67], v[124:127], v[216:219], v[64:67]
    v_sub_f32 v6, 0, v6
    s_waitcnt lgkmcnt(6)
    v_mfma_f32_16x16x32_bf16 v[56:59], v[44:47], v[224:227], v[56:59]
    ds_read_b128 v[96:99], v15 offset:2048
    v_mul_f32 v2, 0xbfb8aa3b, v2
    v_mfma_f32_16x16x32_bf16 v[60:63], v[44:47], v[228:231], v[60:63]
    v_mul_f32 v3, 0xbfb8aa3b, v3
    v_mfma_f32_16x16x32_bf16 v[68:71], v[32:35], v[228:231], v[68:71]
    ds_read_b128 v[100:103], v15 offset:3072
    v_mfma_f32_16x16x32_bf16 v[64:67], v[32:35], v[224:227], v[64:67]
    v_mfma_f32_16x16x32_bf16 v[56:59], v[36:39], v[232:235], v[56:59]
    ds_read_b128 v[120:123], v15 offset:4096
    v_mfma_f32_16x16x32_bf16 v[60:63], v[36:39], v[236:239], v[60:63]
    v_mfma_f32_16x16x32_bf16 v[68:71], v[40:43], v[236:239], v[68:71]
    ds_read_b128 v[124:127], v15 offset:5120
    v_mfma_f32_16x16x32_bf16 v[64:67], v[40:43], v[232:235], v[64:67]
    s_waitcnt lgkmcnt(6)
    v_mfma_f32_16x16x32_bf16 v[56:59], v[88:91], v[240:243], v[56:59]
    ds_read_b128 v[44:47], v15 offset:6144
    v_mfma_f32_16x16x32_bf16 v[60:63], v[88:91], v[244:247], v[60:63]
    v_mfma_f32_16x16x32_bf16 v[68:71], v[92:95], v[244:247], v[68:71]
    ds_read_b128 v[32:35], v15 offset:7168
    v_mfma_f32_16x16x32_bf16 v[64:67], v[92:95], v[240:243], v[64:67]
    v_mfma_f32_16x16x32_bf16 v[56:59], v[104:107], v[248:251], v[56:59]
    ds_read_b128 v[36:39], v15 offset:8192
    v_mfma_f32_16x16x32_bf16 v[60:63], v[104:107], v[252:255], v[60:63]
    v_mfma_f32_16x16x32_bf16 v[68:71], v[108:111], v[252:255], v[68:71]
    ds_read_b128 v[40:43], v15 offset:9216
    v_mfma_f32_16x16x32_bf16 v[64:67], v[108:111], v[248:251], v[64:67]
    s_waitcnt lgkmcnt(6)
    s_barrier
    v_mfma_f32_16x16x32_bf16 v[72:75], v[112:115], v[128:131], 0
    ds_read_b128 v[88:91], v15 offset:10240
    v_mfma_f32_16x16x32_bf16 v[76:79], v[112:115], v[132:135], 0
    v_mfma_f32_16x16x32_bf16 v[84:87], v[116:119], v[132:135], 0
    ds_read_b128 v[92:95], v15 offset:11264
    v_mfma_f32_16x16x32_bf16 v[80:83], v[116:119], v[128:131], 0
    v_mul_f32 v16, v2, v56
    v_mfma_f32_16x16x32_bf16 v[72:75], v[96:99], v[136:139], v[72:75]
    ds_read_b128 v[104:107], v15 offset:12288
    v_mul_f32_e64 v17, v2, v57
    v_mfma_f32_16x16x32_bf16 v[76:79], v[96:99], v[140:143], v[76:79]
    v_mul_f32 v18, v2, v58
    v_mul_f32 v19, v2, v59
    v_mfma_f32_16x16x32_bf16 v[84:87], v[100:103], v[140:143], v[84:87]
    ds_read_b128 v[108:111], v15 offset:13312
    v_mfma_f32_16x16x32_bf16 v[80:83], v[100:103], v[136:139], v[80:83]
    v_exp_f32 v16, v16
    s_waitcnt lgkmcnt(6)
    v_mfma_f32_16x16x32_bf16 v[72:75], v[120:123], v[144:147], v[72:75]
    ds_read_b128 v[112:115], v15 offset:14336
    v_mul_f32_e64 v24, v56, v64
    v_mfma_f32_16x16x32_bf16 v[76:79], v[120:123], v[148:151], v[76:79]
    v_mfma_f32_16x16x32_bf16 v[84:87], v[124:127], v[148:151], v[84:87]
    ds_read_b128 v[116:119], v15 offset:15360
    v_exp_f32_e64 v17, v17
    v_mfma_f32_16x16x32_bf16 v[80:83], v[124:127], v[144:147], v[80:83]
    v_mul_f32_e64 v25, v57, v65
    v_mfma_f32_16x16x32_bf16 v[72:75], v[44:47], v[152:155], v[72:75]
    ds_read_b128 v[96:99], v15 offset:16384
    v_exp_f32_e64 v18, v18
    v_mfma_f32_16x16x32_bf16 v[76:79], v[44:47], v[156:159], v[76:79]
    v_mul_f32_e64 v26, v58, v66
    v_mfma_f32_16x16x32_bf16 v[84:87], v[32:35], v[156:159], v[84:87]
    ds_read_b128 v[100:103], v15 offset:17408
    v_mfma_f32_16x16x32_bf16 v[80:83], v[32:35], v[152:155], v[80:83]
    v_exp_f32 v19, v19
    s_waitcnt lgkmcnt(6)
    v_mfma_f32_16x16x32_bf16 v[72:75], v[36:39], v[160:163], v[72:75]
    ds_read_b128 v[120:123], v15 offset:18432
    v_mul_f32_e64 v27, v59, v67
    v_mfma_f32_16x16x32_bf16 v[76:79], v[36:39], v[164:167], v[76:79]
    v_fma_f32 v16, v16, v4, v4
    v_fma_f32 v17, v17, v4, v4
    v_mfma_f32_16x16x32_bf16 v[84:87], v[40:43], v[164:167], v[84:87]
    ds_read_b128 v[124:127], v15 offset:19456
    v_fma_f32 v18, v18, v4, v4
    v_mfma_f32_16x16x32_bf16 v[80:83], v[40:43], v[160:163], v[80:83]
    v_fma_f32 v19, v19, v4, v4
    v_mfma_f32_16x16x32_bf16 v[72:75], v[88:91], v[168:171], v[72:75]
    ds_read_b128 v[44:47], v15 offset:20480
    v_mfma_f32_16x16x32_bf16 v[76:79], v[88:91], v[172:175], v[76:79]
    v_rcp_f32_e64 v16, v16
    v_mfma_f32_16x16x32_bf16 v[84:87], v[92:95], v[172:175], v[84:87]
    ds_read_b128 v[32:35], v15 offset:21504
    v_mfma_f32_16x16x32_bf16 v[80:83], v[92:95], v[168:171], v[80:83]
    v_rcp_f32 v17, v17
    s_waitcnt lgkmcnt(6)
    v_mfma_f32_16x16x32_bf16 v[72:75], v[104:107], v[176:179], v[72:75]
    ds_read_b128 v[36:39], v15 offset:22528
    v_rcp_f32_e64 v18, v18
    v_mfma_f32_16x16x32_bf16 v[76:79], v[104:107], v[180:183], v[76:79]
    v_mfma_f32_16x16x32_bf16 v[84:87], v[108:111], v[180:183], v[84:87]
    ds_read_b128 v[40:43], v15 offset:23552
    v_rcp_f32_e64 v19, v19
    v_mfma_f32_16x16x32_bf16 v[80:83], v[108:111], v[176:179], v[80:83]
    v_mul_f32_e64 v16, v16, v24
    v_mfma_f32_16x16x32_bf16 v[72:75], v[112:115], v[184:187], v[72:75]
    ds_read_b128 v[88:91], v15 offset:24576
    v_mul_f32_e64 v17, v17, v25
    v_mfma_f32_16x16x32_bf16 v[76:79], v[112:115], v[188:191], v[76:79]
    v_mul_f32 v18, v18, v26
    v_mul_f32 v19, v19, v27
    v_mfma_f32_16x16x32_bf16 v[84:87], v[116:119], v[188:191], v[84:87]
    ds_read_b128 v[92:95], v15 offset:25600
    v_cvt_pk_bf16_f32 v48, v16, v17
    v_mfma_f32_16x16x32_bf16 v[80:83], v[116:119], v[184:187], v[80:83]
    v_cvt_pk_bf16_f32 v49, v18, v19
    s_waitcnt lgkmcnt(6)
    v_mfma_f32_16x16x32_bf16 v[72:75], v[96:99], v[192:195], v[72:75]
    ds_read_b128 v[104:107], v15 offset:26624
    v_mul_f32 v20, v3, v60
    v_mfma_f32_16x16x32_bf16 v[76:79], v[96:99], v[196:199], v[76:79]
    v_mul_f32_e64 v21, v3, v61
    v_mfma_f32_16x16x32_bf16 v[84:87], v[100:103], v[196:199], v[84:87]
    ds_read_b128 v[108:111], v15 offset:27648
    v_mul_f32 v22, v3, v62
    v_mul_f32 v23, v3, v63
    v_mfma_f32_16x16x32_bf16 v[80:83], v[100:103], v[192:195], v[80:83]
    v_mfma_f32_16x16x32_bf16 v[72:75], v[120:123], v[200:203], v[72:75]
    ds_read_b128 v[112:115], v15 offset:28672
    v_exp_f32_e64 v20, v20
    v_mfma_f32_16x16x32_bf16 v[76:79], v[120:123], v[204:207], v[76:79]
    v_mul_f32_e64 v28, v60, v68
    v_mfma_f32_16x16x32_bf16 v[84:87], v[124:127], v[204:207], v[84:87]
    ds_read_b128 v[116:119], v15 offset:29696
    v_mfma_f32_16x16x32_bf16 v[80:83], v[124:127], v[200:203], v[80:83]
    v_exp_f32 v21, v21
    s_waitcnt lgkmcnt(6)
    v_mfma_f32_16x16x32_bf16 v[72:75], v[44:47], v[208:211], v[72:75]
    ds_read_b128 v[96:99], v15 offset:30720
    v_mul_f32_e64 v29, v61, v69
    v_mfma_f32_16x16x32_bf16 v[76:79], v[44:47], v[212:215], v[76:79]
    v_exp_f32_e64 v22, v22
    v_mfma_f32_16x16x32_bf16 v[84:87], v[32:35], v[212:215], v[84:87]
    ds_read_b128 v[100:103], v15 offset:31744
    v_mul_f32_e64 v30, v62, v70
    v_mfma_f32_16x16x32_bf16 v[80:83], v[32:35], v[208:211], v[80:83]
    v_mfma_f32_16x16x32_bf16 v[72:75], v[36:39], v[216:219], v[72:75]
    ds_read_b128 v[120:123], v1 offset:0
    v_exp_f32_e64 v23, v23
    v_mfma_f32_16x16x32_bf16 v[76:79], v[36:39], v[220:223], v[76:79]
    v_mul_f32_e64 v31, v63, v71
    v_mfma_f32_16x16x32_bf16 v[84:87], v[40:43], v[220:223], v[84:87]
    ds_read_b128 v[124:127], v1 offset:1024
    v_fma_f32 v20, v20, v5, v5
    v_fma_f32 v21, v21, v5, v5
    v_mfma_f32_16x16x32_bf16 v[80:83], v[40:43], v[216:219], v[80:83]
    v_fma_f32 v22, v22, v5, v5
    s_waitcnt lgkmcnt(6)
    v_mfma_f32_16x16x32_bf16 v[72:75], v[88:91], v[224:227], v[72:75]
    ds_read_b128 v[44:47], v1 offset:2048
    v_fma_f32 v23, v23, v5, v5
    v_mfma_f32_16x16x32_bf16 v[76:79], v[88:91], v[228:231], v[76:79]
    v_mfma_f32_16x16x32_bf16 v[84:87], v[92:95], v[228:231], v[84:87]
    ds_read_b128 v[32:35], v1 offset:3072
    v_rcp_f32 v20, v20
    v_mfma_f32_16x16x32_bf16 v[80:83], v[92:95], v[224:227], v[80:83]
    v_mfma_f32_16x16x32_bf16 v[72:75], v[104:107], v[232:235], v[72:75]
    ds_read_b128 v[36:39], v1 offset:4096
    v_rcp_f32_e64 v21, v21
    v_mfma_f32_16x16x32_bf16 v[76:79], v[104:107], v[236:239], v[76:79]
    v_rcp_f32_e64 v22, v22
    v_mfma_f32_16x16x32_bf16 v[84:87], v[108:111], v[236:239], v[84:87]
    ds_read_b128 v[40:43], v1 offset:5120
    v_mfma_f32_16x16x32_bf16 v[80:83], v[108:111], v[232:235], v[80:83]
    v_rcp_f32 v23, v23
    s_waitcnt lgkmcnt(6)
    v_mfma_f32_16x16x32_bf16 v[72:75], v[112:115], v[240:243], v[72:75]
    ds_read_b128 v[88:91], v1 offset:6144
    v_mul_f32_e64 v20, v20, v28
    v_mfma_f32_16x16x32_bf16 v[76:79], v[112:115], v[244:247], v[76:79]
    v_mul_f32_e64 v21, v21, v29
    v_mfma_f32_16x16x32_bf16 v[84:87], v[116:119], v[244:247], v[84:87]
    ds_read_b128 v[92:95], v1 offset:7168
    v_mul_f32 v22, v22, v30
    v_mul_f32 v23, v23, v31
    v_mfma_f32_16x16x32_bf16 v[80:83], v[116:119], v[240:243], v[80:83]
    v_cvt_pk_bf16_f32 v52, v20, v21
    v_mfma_f32_16x16x32_bf16 v[72:75], v[96:99], v[248:251], v[72:75]
    ds_read_b128 v[104:107], v1 offset:8192
    v_cvt_pk_bf16_f32 v53, v22, v23
    v_mfma_f32_16x16x32_bf16 v[76:79], v[96:99], v[252:255], v[76:79]
    v_mfma_f32_16x16x32_bf16 v[84:87], v[100:103], v[252:255], v[84:87]
    ds_read_b128 v[108:111], v1 offset:9216
    v_mfma_f32_16x16x32_bf16 v[80:83], v[100:103], v[248:251], v[80:83]
    s_waitcnt lgkmcnt(6)
    s_barrier
    v_mfma_f32_16x16x32_bf16 v[56:59], v[120:123], v[128:131], 0
    ds_read_b128 v[112:115], v1 offset:10240
    v_mfma_f32_16x16x32_bf16 v[60:63], v[120:123], v[132:135], 0
    v_mfma_f32_16x16x32_bf16 v[68:71], v[124:127], v[132:135], 0
    ds_read_b128 v[116:119], v1 offset:11264
    v_mfma_f32_16x16x32_bf16 v[64:67], v[124:127], v[128:131], 0
    v_mul_f32_e64 v16, v2, v72
    v_mfma_f32_16x16x32_bf16 v[56:59], v[44:47], v[136:139], v[56:59]
    ds_read_b128 v[96:99], v1 offset:12288
    v_mul_f32_e64 v17, v2, v73
    v_mfma_f32_16x16x32_bf16 v[60:63], v[44:47], v[140:143], v[60:63]
    v_mul_f32 v18, v2, v74
    v_mul_f32 v19, v2, v75
    v_mfma_f32_16x16x32_bf16 v[68:71], v[32:35], v[140:143], v[68:71]
    ds_read_b128 v[100:103], v1 offset:13312
    v_mfma_f32_16x16x32_bf16 v[64:67], v[32:35], v[136:139], v[64:67]
    v_exp_f32 v16, v16
    s_waitcnt lgkmcnt(6)
    v_mfma_f32_16x16x32_bf16 v[56:59], v[36:39], v[144:147], v[56:59]
    ds_read_b128 v[120:123], v1 offset:14336
    v_mul_f32_e64 v24, v72, v80
    v_mfma_f32_16x16x32_bf16 v[60:63], v[36:39], v[148:151], v[60:63]
    v_mfma_f32_16x16x32_bf16 v[68:71], v[40:43], v[148:151], v[68:71]
    ds_read_b128 v[124:127], v1 offset:15360
    v_exp_f32 v17, v17
    v_mul_f32 v25, v73, v81
    v_mfma_f32_16x16x32_bf16 v[64:67], v[40:43], v[144:147], v[64:67]
    v_mfma_f32_16x16x32_bf16 v[56:59], v[88:91], v[152:155], v[56:59]
    ds_read_b128 v[44:47], v1 offset:16384
    v_exp_f32_e64 v18, v18
    v_mfma_f32_16x16x32_bf16 v[60:63], v[88:91], v[156:159], v[60:63]
    v_mul_f32_e64 v26, v74, v82
    v_mfma_f32_16x16x32_bf16 v[68:71], v[92:95], v[156:159], v[68:71]
    ds_read_b128 v[32:35], v1 offset:17408
    v_mfma_f32_16x16x32_bf16 v[64:67], v[92:95], v[152:155], v[64:67]
    v_exp_f32 v19, v19
    v_mul_f32_e64 v27, v75, v83
    s_waitcnt lgkmcnt(6)
    v_mfma_f32_16x16x32_bf16 v[56:59], v[104:107], v[160:163], v[56:59]
    ds_read_b128 v[36:39], v1 offset:18432
    v_fma_f32 v16, v16, v4, v4
    v_mfma_f32_16x16x32_bf16 v[60:63], v[104:107], v[164:167], v[60:63]
    v_fma_f32 v17, v17, v4, v4
    v_mfma_f32_16x16x32_bf16 v[68:71], v[108:111], v[164:167], v[68:71]
    ds_read_b128 v[40:43], v1 offset:19456
    v_fma_f32 v18, v18, v4, v4
    v_mfma_f32_16x16x32_bf16 v[64:67], v[108:111], v[160:163], v[64:67]
    v_fma_f32 v19, v19, v4, v4
    v_mfma_f32_16x16x32_bf16 v[56:59], v[112:115], v[168:171], v[56:59]
    ds_read_b128 v[88:91], v1 offset:20480
    v_rcp_f32_e64 v16, v16
    v_mfma_f32_16x16x32_bf16 v[60:63], v[112:115], v[172:175], v[60:63]
    v_mfma_f32_16x16x32_bf16 v[68:71], v[116:119], v[172:175], v[68:71]
    ds_read_b128 v[92:95], v1 offset:21504
    v_rcp_f32_e64 v17, v17
    v_mfma_f32_16x16x32_bf16 v[64:67], v[116:119], v[168:171], v[64:67]
    s_waitcnt lgkmcnt(6)
    v_mfma_f32_16x16x32_bf16 v[56:59], v[96:99], v[176:179], v[56:59]
    ds_read_b128 v[104:107], v1 offset:22528
    v_rcp_f32 v18, v18
    v_mfma_f32_16x16x32_bf16 v[60:63], v[96:99], v[180:183], v[60:63]
    v_rcp_f32_e64 v19, v19
    v_mfma_f32_16x16x32_bf16 v[68:71], v[100:103], v[180:183], v[68:71]
    ds_read_b128 v[108:111], v1 offset:23552
    v_mul_f32_e64 v16, v16, v24
    v_mfma_f32_16x16x32_bf16 v[64:67], v[100:103], v[176:179], v[64:67]
    v_mul_f32_e64 v17, v17, v25
    v_mfma_f32_16x16x32_bf16 v[56:59], v[120:123], v[184:187], v[56:59]
    ds_read_b128 v[112:115], v1 offset:24576
    v_mul_f32_e64 v18, v18, v26
    v_mfma_f32_16x16x32_bf16 v[60:63], v[120:123], v[188:191], v[60:63]
    v_mul_f32_e64 v19, v19, v27
    v_mfma_f32_16x16x32_bf16 v[68:71], v[124:127], v[188:191], v[68:71]
    ds_read_b128 v[116:119], v1 offset:25600
    v_cvt_pk_bf16_f32 v50, v16, v17
    v_cvt_pk_bf16_f32 v51, v18, v19
    v_mfma_f32_16x16x32_bf16 v[64:67], v[124:127], v[184:187], v[64:67]
    v_mul_f32_e64 v20, v3, v76
    s_waitcnt lgkmcnt(6)
L_stub2:
    s_cbranch_execz L_ret
    v_mfma_f32_16x16x32_bf16 v[56:59], v[44:47], v[192:195], v[56:59]
    ds_read_b128 v[96:99], v1 offset:26624
    v_mul_f32_e64 v21, v3, v77
    v_mfma_f32_16x16x32_bf16 v[60:63], v[44:47], v[196:199], v[60:63]
    v_mul_f32_e64 v22, v3, v78
    v_mfma_f32_16x16x32_bf16 v[68:71], v[32:35], v[196:199], v[68:71]
    ds_read_b128 v[100:103], v1 offset:27648
    v_mul_f32_e64 v23, v3, v79
    v_mfma_f32_16x16x32_bf16 v[64:67], v[32:35], v[192:195], v[64:67]
    v_exp_f32_e64 v20, v20
    v_mfma_f32_16x16x32_bf16 v[56:59], v[36:39], v[200:203], v[56:59]
    ds_read_b128 v[120:123], v1 offset:28672
    v_mul_f32_e64 v28, v76, v84
    v_mfma_f32_16x16x32_bf16 v[60:63], v[36:39], v[204:207], v[60:63]
    v_mfma_f32_16x16x32_bf16 v[68:71], v[40:43], v[204:207], v[68:71]
    ds_read_b128 v[124:127], v1 offset:29696
    v_exp_f32_e64 v21, v21
    v_mfma_f32_16x16x32_bf16 v[64:67], v[40:43], v[200:203], v[64:67]
    v_mul_f32 v29, v77, v85
    s_waitcnt lgkmcnt(6)
    v_mfma_f32_16x16x32_bf16 v[56:59], v[88:91], v[208:211], v[56:59]
    ds_read_b128 v[44:47], v1 offset:30720
    v_exp_f32_e64 v22, v22
    v_mfma_f32_16x16x32_bf16 v[60:63], v[88:91], v[212:215], v[60:63]
    v_mul_f32_e64 v30, v78, v86
    v_mfma_f32_16x16x32_bf16 v[68:71], v[92:95], v[212:215], v[68:71]
    ds_read_b128 v[32:35], v1 offset:31744
    v_mfma_f32_16x16x32_bf16 v[64:67], v[92:95], v[208:211], v[64:67]
    v_exp_f32_e64 v23, v23
    v_mfma_f32_16x16x32_bf16 v[56:59], v[104:107], v[216:219], v[56:59]
    ds_read_b128 v[36:39], v1 offset:32768
    v_mul_f32_e64 v31, v79, v87
    v_mfma_f32_16x16x32_bf16 v[60:63], v[104:107], v[220:223], v[60:63]
    v_fma_f32 v20, v20, v5, v5
    v_fma_f32 v21, v21, v5, v5
    v_mfma_f32_16x16x32_bf16 v[68:71], v[108:111], v[220:223], v[68:71]
    ds_read_b128 v[40:43], v1 offset:33792
    v_fma_f32 v22, v22, v5, v5
    v_mfma_f32_16x16x32_bf16 v[64:67], v[108:111], v[216:219], v[64:67]
    v_fma_f32 v23, v23, v5, v5
    s_waitcnt lgkmcnt(6)
    v_mfma_f32_16x16x32_bf16 v[56:59], v[112:115], v[224:227], v[56:59]
    ds_read_b128 v[88:91], v1 offset:34816
    v_mfma_f32_16x16x32_bf16 v[60:63], v[112:115], v[228:231], v[60:63]
    v_rcp_f32 v20, v20
    v_mfma_f32_16x16x32_bf16 v[68:71], v[116:119], v[228:231], v[68:71]
    ds_read_b128 v[92:95], v1 offset:35840
    v_rcp_f32_e64 v21, v21
    v_mfma_f32_16x16x32_bf16 v[64:67], v[116:119], v[224:227], v[64:67]
    v_mfma_f32_16x16x32_bf16 v[56:59], v[96:99], v[232:235], v[56:59]
    ds_read_b128 v[104:107], v1 offset:36864
    v_rcp_f32_e64 v22, v22
    v_mfma_f32_16x16x32_bf16 v[60:63], v[96:99], v[236:239], v[60:63]
    v_mfma_f32_16x16x32_bf16 v[68:71], v[100:103], v[236:239], v[68:71]
    ds_read_b128 v[108:111], v1 offset:37888
    v_rcp_f32_e64 v23, v23
    v_mfma_f32_16x16x32_bf16 v[64:67], v[100:103], v[232:235], v[64:67]
    v_mul_f32 v20, v20, v28
    v_mul_f32_e64 v21, v21, v29
    s_waitcnt lgkmcnt(6)
    v_mfma_f32_16x16x32_bf16 v[56:59], v[120:123], v[240:243], v[56:59]
    ds_read_b128 v[112:115], v1 offset:38912
    v_mul_f32_e64 v22, v22, v30
    v_mfma_f32_16x16x32_bf16 v[60:63], v[120:123], v[244:247], v[60:63]
    v_mul_f32_e64 v23, v23, v31
    v_mfma_f32_16x16x32_bf16 v[68:71], v[124:127], v[244:247], v[68:71]
    ds_read_b128 v[116:119], v1 offset:39936
    v_cvt_pk_bf16_f32 v54, v20, v21
    v_mfma_f32_16x16x32_bf16 v[64:67], v[124:127], v[240:243], v[64:67]
    v_cvt_pk_bf16_f32 v55, v22, v23
    v_mfma_f32_16x16x32_bf16 v[56:59], v[44:47], v[248:251], v[56:59]
    ds_read_b128 v[96:99], v1 offset:40960
    buffer_store_dwordx4 v[48:51], v1, s[8:11], s36 offen sc1
    s_add_u32 s36, s36, 16384
    v_mfma_f32_16x16x32_bf16 v[60:63], v[44:47], v[252:255], v[60:63]
    buffer_store_dwordx4 v[52:55], v1, s[8:11], s37 offen sc1
    v_mfma_f32_16x16x32_bf16 v[68:71], v[32:35], v[252:255], v[68:71]
    ds_read_b128 v[100:103], v1 offset:41984
    s_add_u32 s37, s37, 16384
    v_mfma_f32_16x16x32_bf16 v[64:67], v[32:35], v[248:251], v[64:67]
    s_waitcnt lgkmcnt(6)
    s_barrier
    v_mfma_f32_16x16x32_bf16 v[72:75], v[36:39], v[128:131], 0
    ds_read_b128 v[120:123], v1 offset:43008
    v_mfma_f32_16x16x32_bf16 v[76:79], v[36:39], v[132:135], 0
    v_mfma_f32_16x16x32_bf16 v[84:87], v[40:43], v[132:135], 0
    ds_read_b128 v[124:127], v1 offset:44032
    v_mfma_f32_16x16x32_bf16 v[80:83], v[40:43], v[128:131], 0
    v_mul_f32_e64 v16, v2, v56
    v_mfma_f32_16x16x32_bf16 v[72:75], v[88:91], v[136:139], v[72:75]
    ds_read_b128 v[44:47], v1 offset:45056
    v_mul_f32_e64 v17, v2, v57
    v_mfma_f32_16x16x32_bf16 v[76:79], v[88:91], v[140:143], v[76:79]
    v_mul_f32 v18, v2, v58
    v_mul_f32 v19, v2, v59
    v_mfma_f32_16x16x32_bf16 v[84:87], v[92:95], v[140:143], v[84:87]
    ds_read_b128 v[32:35], v1 offset:46080
    v_mfma_f32_16x16x32_bf16 v[80:83], v[92:95], v[136:139], v[80:83]
    v_exp_f32 v16, v16
    s_waitcnt lgkmcnt(6)
    v_mfma_f32_16x16x32_bf16 v[72:75], v[104:107], v[144:147], v[72:75]
    ds_read_b128 v[36:39], v1 offset:47104
    v_mul_f32_e64 v24, v56, v64
    v_mfma_f32_16x16x32_bf16 v[76:79], v[104:107], v[148:151], v[76:79]
    v_mfma_f32_16x16x32_bf16 v[84:87], v[108:111], v[148:151], v[84:87]
    ds_read_b128 v[40:43], v1 offset:48128
    v_exp_f32_e64 v17, v17
    v_mfma_f32_16x16x32_bf16 v[80:83], v[108:111], v[144:147], v[80:83]
    v_mul_f32_e64 v25, v57, v65
    v_mfma_f32_16x16x32_bf16 v[72:75], v[112:115], v[152:155], v[72:75]
    ds_read_b128 v[88:91], v1 offset:49152
    v_exp_f32_e64 v18, v18
    v_mfma_f32_16x16x32_bf16 v[76:79], v[112:115], v[156:159], v[76:79]
    v_mul_f32_e64 v26, v58, v66
    v_mfma_f32_16x16x32_bf16 v[84:87], v[116:119], v[156:159], v[84:87]
    ds_read_b128 v[92:95], v1 offset:50176
    v_mfma_f32_16x16x32_bf16 v[80:83], v[116:119], v[152:155], v[80:83]
    v_exp_f32 v19, v19
    s_waitcnt lgkmcnt(6)
    v_mfma_f32_16x16x32_bf16 v[72:75], v[96:99], v[160:163], v[72:75]
    ds_read_b128 v[104:107], v1 offset:51200
    v_mul_f32_e64 v27, v59, v67
    v_mfma_f32_16x16x32_bf16 v[76:79], v[96:99], v[164:167], v[76:79]
    v_fma_f32 v16, v16, v4, v4
    v_fma_f32 v17, v17, v4, v4
    v_mfma_f32_16x16x32_bf16 v[84:87], v[100:103], v[164:167], v[84:87]
    ds_read_b128 v[108:111], v1 offset:52224
    v_fma_f32 v18, v18, v4, v4
    v_mfma_f32_16x16x32_bf16 v[80:83], v[100:103], v[160:163], v[80:83]
    v_fma_f32 v19, v19, v4, v4
    v_mfma_f32_16x16x32_bf16 v[72:75], v[120:123], v[168:171], v[72:75]
    ds_read_b128 v[112:115], v1 offset:53248
    v_mfma_f32_16x16x32_bf16 v[76:79], v[120:123], v[172:175], v[76:79]
    v_rcp_f32_e64 v16, v16
    v_mfma_f32_16x16x32_bf16 v[84:87], v[124:127], v[172:175], v[84:87]
    ds_read_b128 v[116:119], v1 offset:54272
    v_mfma_f32_16x16x32_bf16 v[80:83], v[124:127], v[168:171], v[80:83]
    v_rcp_f32 v17, v17
    s_waitcnt lgkmcnt(6)
    v_mfma_f32_16x16x32_bf16 v[72:75], v[44:47], v[176:179], v[72:75]
    ds_read_b128 v[96:99], v1 offset:55296
    v_rcp_f32_e64 v18, v18
    v_mfma_f32_16x16x32_bf16 v[76:79], v[44:47], v[180:183], v[76:79]
    v_mfma_f32_16x16x32_bf16 v[84:87], v[32:35], v[180:183], v[84:87]
    ds_read_b128 v[100:103], v1 offset:56320
    v_rcp_f32_e64 v19, v19
    v_mfma_f32_16x16x32_bf16 v[80:83], v[32:35], v[176:179], v[80:83]
    v_mul_f32_e64 v16, v16, v24
    v_mfma_f32_16x16x32_bf16 v[72:75], v[36:39], v[184:187], v[72:75]
    ds_read_b128 v[120:123], v1 offset:57344
    v_mul_f32_e64 v17, v17, v25
    v_mfma_f32_16x16x32_bf16 v[76:79], v[36:39], v[188:191], v[76:79]
    v_mul_f32 v18, v18, v26
    v_mul_f32 v19, v19, v27
    v_mfma_f32_16x16x32_bf16 v[84:87], v[40:43], v[188:191], v[84:87]
    ds_read_b128 v[124:127], v1 offset:58368
    v_cvt_pk_bf16_f32 v48, v16, v17
    v_mfma_f32_16x16x32_bf16 v[80:83], v[40:43], v[184:187], v[80:83]
    v_cvt_pk_bf16_f32 v49, v18, v19
    s_waitcnt lgkmcnt(6)
    v_mfma_f32_16x16x32_bf16 v[72:75], v[88:91], v[192:195], v[72:75]
    ds_read_b128 v[44:47], v1 offset:59392
    v_mul_f32 v20, v3, v60
    v_mfma_f32_16x16x32_bf16 v[76:79], v[88:91], v[196:199], v[76:79]
    v_mul_f32_e64 v21, v3, v61
    v_mfma_f32_16x16x32_bf16 v[84:87], v[92:95], v[196:199], v[84:87]
    ds_read_b128 v[32:35], v1 offset:60416
    v_mul_f32 v22, v3, v62
    v_mul_f32 v23, v3, v63
    v_mfma_f32_16x16x32_bf16 v[80:83], v[92:95], v[192:195], v[80:83]
    v_mfma_f32_16x16x32_bf16 v[72:75], v[104:107], v[200:203], v[72:75]
    ds_read_b128 v[36:39], v1 offset:61440
    v_exp_f32_e64 v20, v20
    v_mfma_f32_16x16x32_bf16 v[76:79], v[104:107], v[204:207], v[76:79]
    v_mul_f32_e64 v28, v60, v68
    v_mfma_f32_16x16x32_bf16 v[84:87], v[108:111], v[204:207], v[84:87]
    ds_read_b128 v[40:43], v1 offset:62464
    v_mfma_f32_16x16x32_bf16 v[80:83], v[108:111], v[200:203], v[80:83]
    v_exp_f32 v21, v21
    s_waitcnt lgkmcnt(6)
    v_mfma_f32_16x16x32_bf16 v[72:75], v[112:115], v[208:211], v[72:75]
    ds_read_b128 v[88:91], v1 offset:63488
    v_mul_f32_e64 v29, v61, v69
    v_mfma_f32_16x16x32_bf16 v[76:79], v[112:115], v[212:215], v[76:79]
    v_exp_f32_e64 v22, v22
    v_mfma_f32_16x16x32_bf16 v[84:87], v[116:119], v[212:215], v[84:87]
    ds_read_b128 v[92:95], v1 offset:64512
    v_mul_f32_e64 v30, v62, v70
    v_mfma_f32_16x16x32_bf16 v[80:83], v[116:119], v[208:211], v[80:83]
    v_mfma_f32_16x16x32_bf16 v[72:75], v[96:99], v[216:219], v[72:75]
    ds_read_b128 v[104:107], v14 offset:16384
    v_exp_f32_e64 v23, v23
    v_mfma_f32_16x16x32_bf16 v[76:79], v[96:99], v[220:223], v[76:79]
    v_mul_f32_e64 v31, v63, v71
    v_mfma_f32_16x16x32_bf16 v[84:87], v[100:103], v[220:223], v[84:87]
    ds_read_b128 v[108:111], v14 offset:17408
    v_fma_f32 v20, v20, v5, v5
    v_fma_f32 v21, v21, v5, v5
    v_mfma_f32_16x16x32_bf16 v[80:83], v[100:103], v[216:219], v[80:83]
    v_fma_f32 v22, v22, v5, v5
    s_waitcnt lgkmcnt(6)
    v_mfma_f32_16x16x32_bf16 v[72:75], v[120:123], v[224:227], v[72:75]
    ds_read_b128 v[112:115], v14 offset:18432
    v_fma_f32 v23, v23, v5, v5
    v_mfma_f32_16x16x32_bf16 v[76:79], v[120:123], v[228:231], v[76:79]
    v_mfma_f32_16x16x32_bf16 v[84:87], v[124:127], v[228:231], v[84:87]
    ds_read_b128 v[116:119], v14 offset:19456
    v_rcp_f32 v20, v20
    v_mfma_f32_16x16x32_bf16 v[80:83], v[124:127], v[224:227], v[80:83]
    v_mfma_f32_16x16x32_bf16 v[72:75], v[44:47], v[232:235], v[72:75]
    ds_read_b128 v[96:99], v14 offset:20480
    v_rcp_f32_e64 v21, v21
    v_mfma_f32_16x16x32_bf16 v[76:79], v[44:47], v[236:239], v[76:79]
    v_rcp_f32_e64 v22, v22
    v_mfma_f32_16x16x32_bf16 v[84:87], v[32:35], v[236:239], v[84:87]
    ds_read_b128 v[100:103], v14 offset:21504
    v_mfma_f32_16x16x32_bf16 v[80:83], v[32:35], v[232:235], v[80:83]
    v_rcp_f32 v23, v23
    s_waitcnt lgkmcnt(6)
    v_mfma_f32_16x16x32_bf16 v[72:75], v[36:39], v[240:243], v[72:75]
    ds_read_b128 v[120:123], v14 offset:22528
    v_mul_f32_e64 v20, v20, v28
    v_mfma_f32_16x16x32_bf16 v[76:79], v[36:39], v[244:247], v[76:79]
    v_mul_f32_e64 v21, v21, v29
    v_mfma_f32_16x16x32_bf16 v[84:87], v[40:43], v[244:247], v[84:87]
    ds_read_b128 v[124:127], v14 offset:23552
    v_mul_f32 v22, v22, v30
    v_mul_f32 v23, v23, v31
    v_mfma_f32_16x16x32_bf16 v[80:83], v[40:43], v[240:243], v[80:83]
    v_cvt_pk_bf16_f32 v52, v20, v21
    v_mfma_f32_16x16x32_bf16 v[72:75], v[88:91], v[248:251], v[72:75]
    ds_read_b128 v[44:47], v14 offset:24576
    v_cvt_pk_bf16_f32 v53, v22, v23
    v_mfma_f32_16x16x32_bf16 v[76:79], v[88:91], v[252:255], v[76:79]
    v_mfma_f32_16x16x32_bf16 v[84:87], v[92:95], v[252:255], v[84:87]
    ds_read_b128 v[32:35], v14 offset:25600
    v_mfma_f32_16x16x32_bf16 v[80:83], v[92:95], v[248:251], v[80:83]
    s_waitcnt vmcnt(0)
    buffer_store_dword v10, v7, s[8:11], s56 offen offset:0 sc1
    s_waitcnt lgkmcnt(6)
    s_barrier
    v_mfma_f32_16x16x32_bf16 v[56:59], v[104:107], v[128:131], 0
    ds_read_b128 v[36:39], v14 offset:26624
    v_mfma_f32_16x16x32_bf16 v[60:63], v[104:107], v[132:135], 0
    v_mfma_f32_16x16x32_bf16 v[68:71], v[108:111], v[132:135], 0
    ds_read_b128 v[40:43], v14 offset:27648
    v_mfma_f32_16x16x32_bf16 v[64:67], v[108:111], v[128:131], 0
    v_mul_f32 v16, v2, v72
    v_mfma_f32_16x16x32_bf16 v[56:59], v[112:115], v[136:139], v[56:59]
    ds_read_b128 v[88:91], v14 offset:28672
    v_mul_f32_e64 v17, v2, v73
    v_mfma_f32_16x16x32_bf16 v[60:63], v[112:115], v[140:143], v[60:63]
    v_mul_f32 v18, v2, v74
    v_mul_f32 v19, v2, v75
    v_mfma_f32_16x16x32_bf16 v[68:71], v[116:119], v[140:143], v[68:71]
    ds_read_b128 v[92:95], v14 offset:29696
    v_mfma_f32_16x16x32_bf16 v[64:67], v[116:119], v[136:139], v[64:67]
    v_exp_f32 v16, v16
    s_waitcnt lgkmcnt(6)
    v_mfma_f32_16x16x32_bf16 v[56:59], v[96:99], v[144:147], v[56:59]
    ds_read_b128 v[104:107], v14 offset:30720
    v_mul_f32_e64 v24, v72, v80
    v_mfma_f32_16x16x32_bf16 v[60:63], v[96:99], v[148:151], v[60:63]
    v_mfma_f32_16x16x32_bf16 v[68:71], v[100:103], v[148:151], v[68:71]
    ds_read_b128 v[108:111], v14 offset:31744
    v_exp_f32 v17, v17
    v_mul_f32 v25, v73, v81
    v_mfma_f32_16x16x32_bf16 v[64:67], v[100:103], v[144:147], v[64:67]
    v_mfma_f32_16x16x32_bf16 v[56:59], v[120:123], v[152:155], v[56:59]
    ds_read_b128 v[112:115], v14 offset:32768
    v_exp_f32_e64 v18, v18
    v_mfma_f32_16x16x32_bf16 v[60:63], v[120:123], v[156:159], v[60:63]
    v_mul_f32_e64 v26, v74, v82
    v_mfma_f32_16x16x32_bf16 v[68:71], v[124:127], v[156:159], v[68:71]
    ds_read_b128 v[116:119], v14 offset:33792
    v_mfma_f32_16x16x32_bf16 v[64:67], v[124:127], v[152:155], v[64:67]
    v_exp_f32 v19, v19
    v_mul_f32_e64 v27, v75, v83
    s_waitcnt lgkmcnt(6)
    v_mfma_f32_16x16x32_bf16 v[56:59], v[44:47], v[160:163], v[56:59]
    ds_read_b128 v[96:99], v14 offset:34816
    v_fma_f32 v16, v16, v4, v4
    v_mfma_f32_16x16x32_bf16 v[60:63], v[44:47], v[164:167], v[60:63]
    v_fma_f32 v17, v17, v4, v4
    v_mfma_f32_16x16x32_bf16 v[68:71], v[32:35], v[164:167], v[68:71]
    ds_read_b128 v[100:103], v14 offset:35840
    v_fma_f32 v18, v18, v4, v4
    v_mfma_f32_16x16x32_bf16 v[64:67], v[32:35], v[160:163], v[64:67]
    v_fma_f32 v19, v19, v4, v4
    v_mfma_f32_16x16x32_bf16 v[56:59], v[36:39], v[168:171], v[56:59]
    ds_read_b128 v[120:123], v14 offset:36864
    v_rcp_f32_e64 v16, v16
    v_mfma_f32_16x16x32_bf16 v[60:63], v[36:39], v[172:175], v[60:63]
    v_mfma_f32_16x16x32_bf16 v[68:71], v[40:43], v[172:175], v[68:71]
    ds_read_b128 v[124:127], v14 offset:37888
    v_rcp_f32_e64 v17, v17
    v_mfma_f32_16x16x32_bf16 v[64:67], v[40:43], v[168:171], v[64:67]
    s_waitcnt lgkmcnt(6)
    v_mfma_f32_16x16x32_bf16 v[56:59], v[88:91], v[176:179], v[56:59]
    ds_read_b128 v[44:47], v14 offset:38912
    v_rcp_f32 v18, v18
    v_mfma_f32_16x16x32_bf16 v[60:63], v[88:91], v[180:183], v[60:63]
    v_rcp_f32_e64 v19, v19
    v_mfma_f32_16x16x32_bf16 v[68:71], v[92:95], v[180:183], v[68:71]
    ds_read_b128 v[32:35], v14 offset:39936
    v_mul_f32_e64 v16, v16, v24
    v_mfma_f32_16x16x32_bf16 v[64:67], v[92:95], v[176:179], v[64:67]
    v_mul_f32_e64 v17, v17, v25
    v_mfma_f32_16x16x32_bf16 v[56:59], v[104:107], v[184:187], v[56:59]
    ds_read_b128 v[36:39], v14 offset:40960
    v_mul_f32_e64 v18, v18, v26
    v_mfma_f32_16x16x32_bf16 v[60:63], v[104:107], v[188:191], v[60:63]
    v_mul_f32_e64 v19, v19, v27
    v_mfma_f32_16x16x32_bf16 v[68:71], v[108:111], v[188:191], v[68:71]
    ds_read_b128 v[40:43], v14 offset:41984
    v_cvt_pk_bf16_f32 v50, v16, v17
    v_cvt_pk_bf16_f32 v51, v18, v19
    v_mfma_f32_16x16x32_bf16 v[64:67], v[108:111], v[184:187], v[64:67]
    v_mul_f32 v20, v3, v76
    s_waitcnt lgkmcnt(6)
    v_mfma_f32_16x16x32_bf16 v[56:59], v[112:115], v[192:195], v[56:59]
    ds_read_b128 v[88:91], v14 offset:43008
    v_mul_f32_e64 v21, v3, v77
    v_mfma_f32_16x16x32_bf16 v[60:63], v[112:115], v[196:199], v[60:63]
    v_mul_f32_e64 v22, v3, v78
    v_mfma_f32_16x16x32_bf16 v[68:71], v[116:119], v[196:199], v[68:71]
    ds_read_b128 v[92:95], v14 offset:44032
    v_mul_f32_e64 v23, v3, v79
    v_mfma_f32_16x16x32_bf16 v[64:67], v[116:119], v[192:195], v[64:67]
    v_exp_f32_e64 v20, v20
    v_mfma_f32_16x16x32_bf16 v[56:59], v[96:99], v[200:203], v[56:59]
    ds_read_b128 v[104:107], v14 offset:45056
    v_mul_f32_e64 v28, v76, v84
    v_mfma_f32_16x16x32_bf16 v[60:63], v[96:99], v[204:207], v[60:63]
    v_mfma_f32_16x16x32_bf16 v[68:71], v[100:103], v[204:207], v[68:71]
    ds_read_b128 v[108:111], v14 offset:46080
    v_exp_f32_e64 v21, v21
    v_mfma_f32_16x16x32_bf16 v[64:67], v[100:103], v[200:203], v[64:67]
    v_mul_f32 v29, v77, v85
    s_waitcnt lgkmcnt(6)
    v_mfma_f32_16x16x32_bf16 v[56:59], v[120:123], v[208:211], v[56:59]
    ds_read_b128 v[112:115], v14 offset:47104
    v_exp_f32_e64 v22, v22
    v_mfma_f32_16x16x32_bf16 v[60:63], v[120:123], v[212:215], v[60:63]
    v_mul_f32_e64 v30, v78, v86
    v_mfma_f32_16x16x32_bf16 v[68:71], v[124:127], v[212:215], v[68:71]
    ds_read_b128 v[116:119], v14 offset:48128
    v_mfma_f32_16x16x32_bf16 v[64:67], v[124:127], v[208:211], v[64:67]
    v_exp_f32_e64 v23, v23
    v_mfma_f32_16x16x32_bf16 v[56:59], v[44:47], v[216:219], v[56:59]
    ds_read_b128 v[96:99], v14 offset:0
    v_mul_f32_e64 v31, v79, v87
    v_mfma_f32_16x16x32_bf16 v[60:63], v[44:47], v[220:223], v[60:63]
    v_fma_f32 v20, v20, v5, v5
    v_fma_f32 v21, v21, v5, v5
    v_mfma_f32_16x16x32_bf16 v[68:71], v[32:35], v[220:223], v[68:71]
    ds_read_b128 v[100:103], v14 offset:1024
    v_fma_f32 v22, v22, v5, v5
    v_mfma_f32_16x16x32_bf16 v[64:67], v[32:35], v[216:219], v[64:67]
    v_fma_f32 v23, v23, v5, v5
    s_waitcnt lgkmcnt(6)
    v_mfma_f32_16x16x32_bf16 v[56:59], v[36:39], v[224:227], v[56:59]
    ds_read_b128 v[120:123], v14 offset:2048
    v_mfma_f32_16x16x32_bf16 v[60:63], v[36:39], v[228:231], v[60:63]
    v_rcp_f32 v20, v20
    v_mfma_f32_16x16x32_bf16 v[68:71], v[40:43], v[228:231], v[68:71]
    ds_read_b128 v[124:127], v14 offset:3072
    v_rcp_f32_e64 v21, v21
    v_mfma_f32_16x16x32_bf16 v[64:67], v[40:43], v[224:227], v[64:67]
    v_mfma_f32_16x16x32_bf16 v[56:59], v[88:91], v[232:235], v[56:59]
    ds_read_b128 v[44:47], v14 offset:4096
    v_rcp_f32_e64 v22, v22
    v_mfma_f32_16x16x32_bf16 v[60:63], v[88:91], v[236:239], v[60:63]
    v_mfma_f32_16x16x32_bf16 v[68:71], v[92:95], v[236:239], v[68:71]
    ds_read_b128 v[32:35], v14 offset:5120
    v_rcp_f32_e64 v23, v23
    v_mfma_f32_16x16x32_bf16 v[64:67], v[92:95], v[232:235], v[64:67]
    v_mul_f32 v20, v20, v28
    v_mul_f32_e64 v21, v21, v29
    s_waitcnt lgkmcnt(6)
    v_mfma_f32_16x16x32_bf16 v[56:59], v[104:107], v[240:243], v[56:59]
    ds_read_b128 v[36:39], v14 offset:6144
    v_mul_f32_e64 v22, v22, v30
    v_mfma_f32_16x16x32_bf16 v[60:63], v[104:107], v[244:247], v[60:63]
    v_mul_f32_e64 v23, v23, v31
    v_mfma_f32_16x16x32_bf16 v[68:71], v[108:111], v[244:247], v[68:71]
    ds_read_b128 v[40:43], v14 offset:7168
    v_cvt_pk_bf16_f32 v54, v20, v21
    v_mfma_f32_16x16x32_bf16 v[64:67], v[108:111], v[240:243], v[64:67]
    v_cvt_pk_bf16_f32 v55, v22, v23
    v_mfma_f32_16x16x32_bf16 v[56:59], v[112:115], v[248:251], v[56:59]
    ds_read_b128 v[88:91], v14 offset:8192
    buffer_store_dwordx4 v[48:51], v1, s[8:11], s36 offen sc1
    s_add_u32 s36, s36, 16384
    v_mfma_f32_16x16x32_bf16 v[60:63], v[112:115], v[252:255], v[60:63]
    buffer_store_dwordx4 v[52:55], v1, s[8:11], s37 offen sc1
    v_mfma_f32_16x16x32_bf16 v[68:71], v[116:119], v[252:255], v[68:71]
    ds_read_b128 v[92:95], v14 offset:9216
    s_add_u32 s37, s37, 16384
    v_mfma_f32_16x16x32_bf16 v[64:67], v[116:119], v[248:251], v[64:67]
    s_waitcnt lgkmcnt(6)
    s_barrier
    v_mfma_f32_16x16x32_bf16 v[72:75], v[96:99], v[128:131], 0
    ds_read_b128 v[104:107], v14 offset:10240
    v_mfma_f32_16x16x32_bf16 v[76:79], v[96:99], v[132:135], 0
    v_mfma_f32_16x16x32_bf16 v[84:87], v[100:103], v[132:135], 0
    ds_read_b128 v[108:111], v14 offset:11264
    v_mfma_f32_16x16x32_bf16 v[80:83], v[100:103], v[128:131], 0
    v_mul_f32_e64 v16, v2, v56
    v_mfma_f32_16x16x32_bf16 v[72:75], v[120:123], v[136:139], v[72:75]
    ds_read_b128 v[112:115], v14 offset:12288
    v_mul_f32_e64 v17, v2, v57
    v_mfma_f32_16x16x32_bf16 v[76:79], v[120:123], v[140:143], v[76:79]
    v_mul_f32 v18, v2, v58
    v_mul_f32 v19, v2, v59
    v_mfma_f32_16x16x32_bf16 v[84:87], v[124:127], v[140:143], v[84:87]
    ds_read_b128 v[116:119], v14 offset:13312
    v_mfma_f32_16x16x32_bf16 v[80:83], v[124:127], v[136:139], v[80:83]
    v_exp_f32 v16, v16
    s_waitcnt lgkmcnt(6)
    v_mfma_f32_16x16x32_bf16 v[72:75], v[44:47], v[144:147], v[72:75]
    ds_read_b128 v[96:99], v14 offset:14336
    v_mul_f32_e64 v24, v56, v64
    v_mfma_f32_16x16x32_bf16 v[76:79], v[44:47], v[148:151], v[76:79]
    v_mfma_f32_16x16x32_bf16 v[84:87], v[32:35], v[148:151], v[84:87]
    ds_read_b128 v[100:103], v14 offset:15360
    v_exp_f32_e64 v17, v17
    v_mfma_f32_16x16x32_bf16 v[80:83], v[32:35], v[144:147], v[80:83]
    v_mul_f32_e64 v25, v57, v65
    v_mfma_f32_16x16x32_bf16 v[72:75], v[36:39], v[152:155], v[72:75]
    ds_read_b128 v[120:123], v14 offset:49152
    v_exp_f32_e64 v18, v18
    v_mfma_f32_16x16x32_bf16 v[76:79], v[36:39], v[156:159], v[76:79]
    v_mul_f32_e64 v26, v58, v66
    v_mfma_f32_16x16x32_bf16 v[84:87], v[40:43], v[156:159], v[84:87]
    ds_read_b128 v[124:127], v14 offset:50176
    v_mfma_f32_16x16x32_bf16 v[80:83], v[40:43], v[152:155], v[80:83]
    v_exp_f32 v19, v19
    s_waitcnt lgkmcnt(6)
    v_mfma_f32_16x16x32_bf16 v[72:75], v[88:91], v[160:163], v[72:75]
    ds_read_b128 v[44:47], v14 offset:51200
    v_mul_f32_e64 v27, v59, v67
    v_mfma_f32_16x16x32_bf16 v[76:79], v[88:91], v[164:167], v[76:79]
    v_fma_f32 v16, v16, v4, v4
    v_fma_f32 v17, v17, v4, v4
    v_mfma_f32_16x16x32_bf16 v[84:87], v[92:95], v[164:167], v[84:87]
    ds_read_b128 v[32:35], v14 offset:52224
    v_fma_f32 v18, v18, v4, v4
    v_mfma_f32_16x16x32_bf16 v[80:83], v[92:95], v[160:163], v[80:83]
    v_fma_f32 v19, v19, v4, v4
    v_mfma_f32_16x16x32_bf16 v[72:75], v[104:107], v[168:171], v[72:75]
    ds_read_b128 v[36:39], v14 offset:53248
    v_mfma_f32_16x16x32_bf16 v[76:79], v[104:107], v[172:175], v[76:79]
    v_rcp_f32_e64 v16, v16
    v_mfma_f32_16x16x32_bf16 v[84:87], v[108:111], v[172:175], v[84:87]
    ds_read_b128 v[40:43], v14 offset:54272
    v_mfma_f32_16x16x32_bf16 v[80:83], v[108:111], v[168:171], v[80:83]
    v_rcp_f32 v17, v17
    s_waitcnt lgkmcnt(6)
    v_mfma_f32_16x16x32_bf16 v[72:75], v[112:115], v[176:179], v[72:75]
    ds_read_b128 v[88:91], v14 offset:55296
    v_rcp_f32_e64 v18, v18
    v_mfma_f32_16x16x32_bf16 v[76:79], v[112:115], v[180:183], v[76:79]
    v_mfma_f32_16x16x32_bf16 v[84:87], v[116:119], v[180:183], v[84:87]
    ds_read_b128 v[92:95], v14 offset:56320
    v_rcp_f32_e64 v19, v19
    v_mfma_f32_16x16x32_bf16 v[80:83], v[116:119], v[176:179], v[80:83]
    v_mul_f32_e64 v16, v16, v24
    v_mfma_f32_16x16x32_bf16 v[72:75], v[96:99], v[184:187], v[72:75]
    ds_read_b128 v[104:107], v14 offset:57344
    v_mul_f32_e64 v17, v17, v25
    v_mfma_f32_16x16x32_bf16 v[76:79], v[96:99], v[188:191], v[76:79]
    v_mul_f32 v18, v18, v26
    v_mul_f32 v19, v19, v27
    v_mfma_f32_16x16x32_bf16 v[84:87], v[100:103], v[188:191], v[84:87]
    ds_read_b128 v[108:111], v14 offset:58368
    v_cvt_pk_bf16_f32 v48, v16, v17
    v_mfma_f32_16x16x32_bf16 v[80:83], v[100:103], v[184:187], v[80:83]
    v_cvt_pk_bf16_f32 v49, v18, v19
    s_waitcnt lgkmcnt(6)
    v_mfma_f32_16x16x32_bf16 v[72:75], v[120:123], v[192:195], v[72:75]
    ds_read_b128 v[112:115], v14 offset:59392
    v_mul_f32 v20, v3, v60
    v_mfma_f32_16x16x32_bf16 v[76:79], v[120:123], v[196:199], v[76:79]
    v_mul_f32_e64 v21, v3, v61
    v_mfma_f32_16x16x32_bf16 v[84:87], v[124:127], v[196:199], v[84:87]
    ds_read_b128 v[116:119], v14 offset:60416
    v_mul_f32 v22, v3, v62
    v_mul_f32 v23, v3, v63
    v_mfma_f32_16x16x32_bf16 v[80:83], v[124:127], v[192:195], v[80:83]
    v_mfma_f32_16x16x32_bf16 v[72:75], v[44:47], v[200:203], v[72:75]
    ds_read_b128 v[96:99], v14 offset:61440
    v_exp_f32_e64 v20, v20
    v_mfma_f32_16x16x32_bf16 v[76:79], v[44:47], v[204:207], v[76:79]
    v_mul_f32_e64 v28, v60, v68
    v_mfma_f32_16x16x32_bf16 v[84:87], v[32:35], v[204:207], v[84:87]
    ds_read_b128 v[100:103], v14 offset:62464
    v_mfma_f32_16x16x32_bf16 v[80:83], v[32:35], v[200:203], v[80:83]
    v_exp_f32 v21, v21
    s_waitcnt lgkmcnt(6)
    v_mfma_f32_16x16x32_bf16 v[72:75], v[36:39], v[208:211], v[72:75]
    ds_read_b128 v[120:123], v14 offset:63488
    v_mul_f32_e64 v29, v61, v69
    v_mfma_f32_16x16x32_bf16 v[76:79], v[36:39], v[212:215], v[76:79]
    v_exp_f32_e64 v22, v22
    v_mfma_f32_16x16x32_bf16 v[84:87], v[40:43], v[212:215], v[84:87]
    ds_read_b128 v[124:127], v14 offset:64512
    v_mul_f32_e64 v30, v62, v70
    v_mfma_f32_16x16x32_bf16 v[80:83], v[40:43], v[208:211], v[80:83]
    v_mfma_f32_16x16x32_bf16 v[72:75], v[88:91], v[216:219], v[72:75]
    ds_read_b128 v[44:47], v15 offset:0
    v_exp_f32_e64 v23, v23
    v_mfma_f32_16x16x32_bf16 v[76:79], v[88:91], v[220:223], v[76:79]
    v_mul_f32_e64 v31, v63, v71
    v_mfma_f32_16x16x32_bf16 v[84:87], v[92:95], v[220:223], v[84:87]
    ds_read_b128 v[32:35], v15 offset:1024
    v_fma_f32 v20, v20, v5, v5
    v_fma_f32 v21, v21, v5, v5
    v_mfma_f32_16x16x32_bf16 v[80:83], v[92:95], v[216:219], v[80:83]
    v_fma_f32 v22, v22, v5, v5
    s_waitcnt vmcnt(0)
    buffer_store_dword v10, v7, s[8:11], s56 offen offset:128 sc1
    s_waitcnt lgkmcnt(6)
    v_mfma_f32_16x16x32_bf16 v[72:75], v[104:107], v[224:227], v[72:75]
    ds_read_b128 v[36:39], v15 offset:2048
    v_fma_f32 v23, v23, v5, v5
    v_mfma_f32_16x16x32_bf16 v[76:79], v[104:107], v[228:231], v[76:79]
    v_mfma_f32_16x16x32_bf16 v[84:87], v[108:111], v[228:231], v[84:87]
    ds_read_b128 v[40:43], v15 offset:3072
    v_rcp_f32_e64 v20, v20
    v_mfma_f32_16x16x32_bf16 v[80:83], v[108:111], v[224:227], v[80:83]
    v_mfma_f32_16x16x32_bf16 v[72:75], v[112:115], v[232:235], v[72:75]
    ds_read_b128 v[88:91], v15 offset:4096
    v_rcp_f32_e64 v21, v21
    v_mfma_f32_16x16x32_bf16 v[76:79], v[112:115], v[236:239], v[76:79]
    v_rcp_f32_e64 v22, v22
    v_mfma_f32_16x16x32_bf16 v[84:87], v[116:119], v[236:239], v[84:87]
    ds_read_b128 v[92:95], v15 offset:5120
    v_mfma_f32_16x16x32_bf16 v[80:83], v[116:119], v[232:235], v[80:83]
    v_rcp_f32 v23, v23
    s_waitcnt lgkmcnt(6)
    v_mfma_f32_16x16x32_bf16 v[72:75], v[96:99], v[240:243], v[72:75]
    ds_read_b128 v[104:107], v15 offset:6144
    v_mul_f32_e64 v20, v20, v28
    v_mfma_f32_16x16x32_bf16 v[76:79], v[96:99], v[244:247], v[76:79]
    v_mul_f32_e64 v21, v21, v29
    v_mfma_f32_16x16x32_bf16 v[84:87], v[100:103], v[244:247], v[84:87]
    ds_read_b128 v[108:111], v15 offset:7168
L_stub3:
    s_cbranch_execz L_ret
    v_mul_f32 v22, v22, v30
    v_mul_f32_e64 v23, v23, v31
    v_mfma_f32_16x16x32_bf16 v[80:83], v[100:103], v[240:243], v[80:83]
    v_cvt_pk_bf16_f32 v52, v20, v21
    v_mfma_f32_16x16x32_bf16 v[72:75], v[120:123], v[248:251], v[72:75]
    ds_read_b128 v[112:115], v15 offset:8192
    v_cvt_pk_bf16_f32 v53, v22, v23
    v_mfma_f32_16x16x32_bf16 v[76:79], v[120:123], v[252:255], v[76:79]
    v_mfma_f32_16x16x32_bf16 v[84:87], v[124:127], v[252:255], v[84:87]
    ds_read_b128 v[116:119], v15 offset:9216
    v_mfma_f32_16x16x32_bf16 v[80:83], v[124:127], v[248:251], v[80:83]
    s_waitcnt lgkmcnt(6)
    v_mfma_f32_16x16x32_bf16 v[56:59], v[44:47], v[128:131], 0
    ds_read_b128 v[96:99], v15 offset:10240
    v_mfma_f32_16x16x32_bf16 v[60:63], v[44:47], v[132:135], 0
    v_mfma_f32_16x16x32_bf16 v[68:71], v[32:35], v[132:135], 0
    ds_read_b128 v[100:103], v15 offset:11264
    v_mfma_f32_16x16x32_bf16 v[64:67], v[32:35], v[128:131], 0
    v_mul_f32 v16, v2, v72
    v_mul_f32 v17, v2, v73
    v_mul_f32 v18, v2, v74
    v_mfma_f32_16x16x32_bf16 v[56:59], v[36:39], v[136:139], v[56:59]
    ds_read_b128 v[120:123], v15 offset:12288
    v_mul_f32 v19, v2, v75
    v_exp_f32 v16, v16
    v_mfma_f32_16x16x32_bf16 v[60:63], v[36:39], v[140:143], v[60:63]
    v_mul_f32 v24, v72, v80
    v_exp_f32 v17, v17
    v_mfma_f32_16x16x32_bf16 v[68:71], v[40:43], v[140:143], v[68:71]
    ds_read_b128 v[124:127], v15 offset:13312
    v_mul_f32 v25, v73, v81
    v_exp_f32 v18, v18
    v_mfma_f32_16x16x32_bf16 v[64:67], v[40:43], v[136:139], v[64:67]
    v_mul_f32 v26, v74, v82
    v_exp_f32_e64 v19, v19
    s_waitcnt lgkmcnt(6)
    v_mfma_f32_16x16x32_bf16 v[56:59], v[88:91], v[144:147], v[56:59]
    ds_read_b128 v[44:47], v15 offset:14336
    v_mul_f32_e64 v27, v75, v83
    v_fma_f32 v16, v16, v4, v4
    v_fma_f32 v17, v17, v4, v4
    v_mfma_f32_16x16x32_bf16 v[60:63], v[88:91], v[148:151], v[60:63]
    v_fma_f32 v18, v18, v4, v4
    v_fma_f32 v19, v19, v4, v4
    v_mfma_f32_16x16x32_bf16 v[68:71], v[92:95], v[148:151], v[68:71]
    ds_read_b128 v[32:35], v15 offset:15360
    v_rcp_f32 v16, v16
    v_rcp_f32 v17, v17
    v_mfma_f32_16x16x32_bf16 v[64:67], v[92:95], v[144:147], v[64:67]
    v_rcp_f32_e64 v18, v18
    v_mfma_f32_16x16x32_bf16 v[56:59], v[104:107], v[152:155], v[56:59]
    ds_read_b128 v[36:39], v15 offset:16384
    v_rcp_f32 v19, v19
    v_mul_f32 v16, v16, v24
    v_mul_f32_e64 v17, v17, v25
    v_mfma_f32_16x16x32_bf16 v[60:63], v[104:107], v[156:159], v[60:63]
    v_mul_f32 v18, v18, v26
    v_mul_f32 v19, v19, v27
    v_cvt_pk_bf16_f32 v50, v16, v17
    v_mfma_f32_16x16x32_bf16 v[68:71], v[108:111], v[156:159], v[68:71]
    ds_read_b128 v[40:43], v15 offset:17408
    v_cvt_pk_bf16_f32 v51, v18, v19
    v_mul_f32 v20, v3, v76
    v_mul_f32 v21, v3, v77
    v_mfma_f32_16x16x32_bf16 v[64:67], v[108:111], v[152:155], v[64:67]
    v_mul_f32 v22, v3, v78
    v_mul_f32_e64 v23, v3, v79
    s_waitcnt lgkmcnt(6)
    v_mfma_f32_16x16x32_bf16 v[56:59], v[112:115], v[160:163], v[56:59]
    ds_read_b128 v[88:91], v15 offset:18432
    v_exp_f32 v20, v20
    v_mul_f32 v28, v76, v84
    v_mfma_f32_16x16x32_bf16 v[60:63], v[112:115], v[164:167], v[60:63]
    v_exp_f32 v21, v21
    v_mul_f32 v29, v77, v85
    v_mfma_f32_16x16x32_bf16 v[68:71], v[116:119], v[164:167], v[68:71]
    ds_read_b128 v[92:95], v15 offset:19456
    v_exp_f32 v22, v22
    v_mul_f32 v30, v78, v86
    v_mfma_f32_16x16x32_bf16 v[64:67], v[116:119], v[160:163], v[64:67]
    v_exp_f32 v23, v23
    v_mul_f32 v31, v79, v87
    v_fma_f32 v20, v20, v5, v5
    v_mfma_f32_16x16x32_bf16 v[56:59], v[96:99], v[168:171], v[56:59]
    ds_read_b128 v[104:107], v15 offset:20480
    v_fma_f32 v21, v21, v5, v5
    v_fma_f32 v22, v22, v5, v5
    v_fma_f32 v23, v23, v5, v5
    v_mfma_f32_16x16x32_bf16 v[60:63], v[96:99], v[172:175], v[60:63]
    v_rcp_f32_e64 v20, v20
    v_mfma_f32_16x16x32_bf16 v[68:71], v[100:103], v[172:175], v[68:71]
    ds_read_b128 v[108:111], v15 offset:21504
    v_rcp_f32 v21, v21
    v_rcp_f32 v22, v22
    v_mfma_f32_16x16x32_bf16 v[64:67], v[100:103], v[168:171], v[64:67]
    v_rcp_f32 v23, v23
    v_mul_f32_e64 v20, v20, v28
    s_waitcnt lgkmcnt(6)
    v_mfma_f32_16x16x32_bf16 v[56:59], v[120:123], v[176:179], v[56:59]
    ds_read_b128 v[112:115], v15 offset:22528
    v_mul_f32 v21, v21, v29
    v_mul_f32 v22, v22, v30
    v_mul_f32_e64 v23, v23, v31
    v_mfma_f32_16x16x32_bf16 v[60:63], v[120:123], v[180:183], v[60:63]
    v_cvt_pk_bf16_f32 v54, v20, v21
    v_cvt_pk_bf16_f32 v55, v22, v23
    buffer_store_dwordx4 v[48:51], v1, s[8:11], s36 offen sc1
    v_mfma_f32_16x16x32_bf16 v[68:71], v[124:127], v[180:183], v[68:71]
    ds_read_b128 v[116:119], v15 offset:23552
    s_add_u32 s36, s36, 16384
    buffer_store_dwordx4 v[52:55], v1, s[8:11], s37 offen sc1
    s_add_u32 s37, s37, 16384
    v_mfma_f32_16x16x32_bf16 v[64:67], v[124:127], v[176:179], v[64:67]
    v_mfma_f32_16x16x32_bf16 v[56:59], v[44:47], v[184:187], v[56:59]
    ds_read_b128 v[96:99], v15 offset:24576
    v_mfma_f32_16x16x32_bf16 v[60:63], v[44:47], v[188:191], v[60:63]
    v_mfma_f32_16x16x32_bf16 v[68:71], v[32:35], v[188:191], v[68:71]
    ds_read_b128 v[100:103], v15 offset:25600
    v_mfma_f32_16x16x32_bf16 v[64:67], v[32:35], v[184:187], v[64:67]
    s_waitcnt lgkmcnt(6)
    v_mfma_f32_16x16x32_bf16 v[56:59], v[36:39], v[192:195], v[56:59]
    ds_read_b128 v[120:123], v15 offset:26624
    v_mfma_f32_16x16x32_bf16 v[60:63], v[36:39], v[196:199], v[60:63]
    v_mfma_f32_16x16x32_bf16 v[68:71], v[40:43], v[196:199], v[68:71]
    ds_read_b128 v[124:127], v15 offset:27648
    v_mfma_f32_16x16x32_bf16 v[64:67], v[40:43], v[192:195], v[64:67]
    v_mfma_f32_16x16x32_bf16 v[56:59], v[88:91], v[200:203], v[56:59]
    ds_read_b128 v[44:47], v15 offset:28672
    v_mfma_f32_16x16x32_bf16 v[60:63], v[88:91], v[204:207], v[60:63]
    v_mfma_f32_16x16x32_bf16 v[68:71], v[92:95], v[204:207], v[68:71]
    ds_read_b128 v[32:35], v15 offset:29696
    v_mfma_f32_16x16x32_bf16 v[64:67], v[92:95], v[200:203], v[64:67]
    s_waitcnt lgkmcnt(6)
    v_mfma_f32_16x16x32_bf16 v[56:59], v[104:107], v[208:211], v[56:59]
    ds_read_b128 v[36:39], v15 offset:30720
    v_mfma_f32_16x16x32_bf16 v[60:63], v[104:107], v[212:215], v[60:63]
    v_mfma_f32_16x16x32_bf16 v[68:71], v[108:111], v[212:215], v[68:71]
    ds_read_b128 v[40:43], v15 offset:31744
    v_mfma_f32_16x16x32_bf16 v[64:67], v[108:111], v[208:211], v[64:67]
    v_mfma_f32_16x16x32_bf16 v[56:59], v[112:115], v[216:219], v[56:59]
    v_mfma_f32_16x16x32_bf16 v[60:63], v[112:115], v[220:223], v[60:63]
    v_mfma_f32_16x16x32_bf16 v[68:71], v[116:119], v[220:223], v[68:71]
    v_mfma_f32_16x16x32_bf16 v[64:67], v[116:119], v[216:219], v[64:67]
    s_waitcnt lgkmcnt(4)
    v_mfma_f32_16x16x32_bf16 v[56:59], v[96:99], v[224:227], v[56:59]
    v_mfma_f32_16x16x32_bf16 v[60:63], v[96:99], v[228:231], v[60:63]
    v_mfma_f32_16x16x32_bf16 v[68:71], v[100:103], v[228:231], v[68:71]
    v_mfma_f32_16x16x32_bf16 v[64:67], v[100:103], v[224:227], v[64:67]
    v_mfma_f32_16x16x32_bf16 v[56:59], v[120:123], v[232:235], v[56:59]
    v_mfma_f32_16x16x32_bf16 v[60:63], v[120:123], v[236:239], v[60:63]
    v_mfma_f32_16x16x32_bf16 v[68:71], v[124:127], v[236:239], v[68:71]
    v_mfma_f32_16x16x32_bf16 v[64:67], v[124:127], v[232:235], v[64:67]
    s_waitcnt lgkmcnt(0)
    v_mfma_f32_16x16x32_bf16 v[56:59], v[44:47], v[240:243], v[56:59]
    v_mfma_f32_16x16x32_bf16 v[60:63], v[44:47], v[244:247], v[60:63]
    v_mfma_f32_16x16x32_bf16 v[68:71], v[32:35], v[244:247], v[68:71]
    v_mfma_f32_16x16x32_bf16 v[64:67], v[32:35], v[240:243], v[64:67]
    v_mfma_f32_16x16x32_bf16 v[56:59], v[36:39], v[248:251], v[56:59]
    v_mfma_f32_16x16x32_bf16 v[60:63], v[36:39], v[252:255], v[60:63]
    v_mfma_f32_16x16x32_bf16 v[68:71], v[40:43], v[252:255], v[68:71]
    v_mfma_f32_16x16x32_bf16 v[64:67], v[40:43], v[248:251], v[64:67]
    s_nop 4
    v_mul_f32 v16, v2, v56
    v_mul_f32 v17, v2, v57
    v_mul_f32 v18, v2, v58
    v_mul_f32 v19, v2, v59
    v_exp_f32 v16, v16
    v_mul_f32 v24, v56, v64
    v_exp_f32 v17, v17
    v_mul_f32 v25, v57, v65
    v_exp_f32 v18, v18
    v_mul_f32 v26, v58, v66
    v_exp_f32 v19, v19
    v_mul_f32_e64 v27, v59, v67
    v_fma_f32 v16, v16, v4, v4
    v_fma_f32 v17, v17, v4, v4
    v_fma_f32 v18, v18, v4, v4
    v_fma_f32 v19, v19, v4, v4
    v_rcp_f32 v16, v16
    v_rcp_f32 v17, v17
    v_rcp_f32 v18, v18
    v_rcp_f32 v19, v19
    v_mul_f32 v16, v16, v24
    v_mul_f32 v17, v17, v25
    v_mul_f32 v18, v18, v26
    v_mul_f32 v19, v19, v27
    v_cvt_pk_bf16_f32 v48, v16, v17
    v_cvt_pk_bf16_f32 v49, v18, v19
    v_mul_f32 v20, v3, v60
    v_mul_f32 v21, v3, v61
    v_mul_f32 v22, v3, v62
    v_mul_f32 v23, v3, v63
    v_exp_f32 v20, v20
    v_mul_f32 v28, v60, v68
    v_exp_f32 v21, v21
    v_mul_f32 v29, v61, v69
    v_exp_f32 v22, v22
    v_mul_f32 v30, v62, v70
    v_exp_f32 v23, v23
    v_mul_f32 v31, v63, v71
    v_fma_f32 v20, v20, v5, v5
    v_fma_f32 v21, v21, v5, v5
    v_fma_f32 v22, v22, v5, v5
    v_fma_f32 v23, v23, v5, v5
    v_rcp_f32 v20, v20
    v_rcp_f32 v21, v21
    v_rcp_f32 v22, v22
    v_rcp_f32 v23, v23
    v_mul_f32 v20, v20, v28
    v_mul_f32 v21, v21, v29
    v_mul_f32 v22, v22, v30
    v_mul_f32 v23, v23, v31
    v_cvt_pk_bf16_f32 v50, v20, v21
    v_cvt_pk_bf16_f32 v51, v22, v23
    s_nop 0
    v_permlane16_swap_b32 v48, v50
    v_permlane16_swap_b32 v49, v51
    buffer_store_dwordx4 v[48:51], v11, s[8:11], s99 offen sc1
    s_waitcnt vmcnt(1)
    buffer_store_dword v10, v7, s[8:11], s56 offen offset:256 sc1
    s_barrier
    v_lshlrev_b32 v2, 4, v13
    ds_bpermute_b32 v28, v2, v6 offset:0
    ds_bpermute_b32 v29, v2, v6 offset:4
    ds_bpermute_b32 v30, v2, v6 offset:8
    ds_bpermute_b32 v31, v2, v6 offset:12
    s_set_gpr_idx_on s12, gpr_idx(SRC0)
    v_mov_b32 v16, v128
    v_mov_b32 v17, v129
    v_mov_b32 v18, v130
    v_mov_b32 v19, v131
    v_mov_b32 v20, v136
    v_mov_b32 v21, v137
    v_mov_b32 v22, v138
    v_mov_b32 v23, v139
    s_set_gpr_idx_off
    s_set_gpr_idx_on s13, gpr_idx(SRC0)
    v_mov_b32 v24, v128
    v_mov_b32 v25, v129
    v_mov_b32 v26, v130
    v_mov_b32 v27, v131
    s_set_gpr_idx_off
    s_cmp_eq_u32 s15, 0
    s_cselect_b32 s28, 1.0, 0
    s_cselect_b32 s29, 0, 1.0
    v_mov_b32 v3, s28
    v_mov_b32_e64 v4, s29
    v_mov_b32 v5, 0x3f80
    v_cndmask_b32 v128, 0, v5, s[44:45]
    v_mov_b32_e64 v129, 0
    v_cndmask_b32 v130, 0, v5, s[46:47]
    v_mov_b32_e64 v131, 0
    v_cndmask_b32 v132, 0, v5, s[48:49]
    v_mov_b32_e64 v133, 0
    v_cndmask_b32 v134, 0, v5, s[50:51]
    v_mov_b32_e64 v135, 0
    v_cndmask_b32 v136, 0, v3, s[52:53]
    v_cndmask_b32 v137, 0, v4, s[52:53]
    v_cndmask_b32 v138, 0, v3, s[54:55]
    v_cndmask_b32 v139, 0, v4, s[54:55]
    v_cndmask_b32 v140, 0, v3, s[4:5]
    v_cndmask_b32 v141, 0, v4, s[4:5]
    v_cndmask_b32 v142, 0, v3, s[18:19]
    v_cndmask_b32 v143, 0, v4, s[18:19]
    v_mov_b32_e64 v144, 0
    v_cndmask_b32 v145, 0, v5, s[52:53]
    v_mov_b32_e64 v146, 0
    v_cndmask_b32 v147, 0, v5, s[54:55]
    s_waitcnt lgkmcnt(0)
    v_mov_b32 v148, 0
    ds_read_b128 v[56:59], v1 offset:0
    v_cndmask_b32 v149, 0, v5, s[4:5]
    ds_read_b128 v[60:63], v1 offset:1024
    v_mov_b32_e64 v150, 0
    ds_read_b128 v[64:67], v1 offset:2048
    v_cndmask_b32 v151, 0, v5, s[18:19]
    ds_read_b128 v[68:71], v1 offset:3072
    v_cndmask_b32 v152, 0, v4, s[52:53]
    ds_read_b128 v[72:75], v1 offset:4096
    v_cndmask_b32 v153, 0, v3, s[52:53]
    ds_read_b128 v[76:79], v1 offset:5120
    v_cndmask_b32 v154, 0, v4, s[54:55]
    ds_read_b128 v[80:83], v1 offset:6144
    v_cndmask_b32 v155, 0, v3, s[54:55]
    ds_read_b128 v[84:87], v1 offset:7168
    v_cndmask_b32 v156, 0, v4, s[4:5]
    ds_read_b128 v[88:91], v1 offset:8192
    v_cndmask_b32 v157, 0, v3, s[4:5]
    ds_read_b128 v[92:95], v1 offset:9216
    v_cndmask_b32 v158, 0, v4, s[18:19]
    ds_read_b128 v[96:99], v1 offset:10240
    v_cndmask_b32 v159, 0, v3, s[18:19]
    ds_read_b128 v[100:103], v1 offset:11264
    v_cndmask_b32 v124, 0, v5, s[38:39]
    ds_read_b128 v[104:107], v1 offset:12288
    v_mov_b32_e64 v125, 0
    ds_read_b128 v[108:111], v1 offset:13312
    v_mov_b32_e64 v126, 0
    ds_read_b128 v[112:115], v1 offset:14336
    v_mov_b32_e64 v127, 0
    ds_read_b128 v[116:119], v1 offset:15360
    v_add_u32_e64 v8, s98, v1
    ds_read_b128 v[120:123], v1 offset:16384
    v_mfma_f32_16x16x32_bf16 v[32:35], v[16:19], v[128:131], v[28:31]
    ds_read_b128 v[160:163], v1 offset:17408
    v_mfma_f32_16x16x32_bf16 v[36:39], v[16:19], v[136:139], v[28:31]
    ds_read_b128 v[164:167], v1 offset:18432
    v_mfma_f32_16x16x32_bf16 v[40:43], v[16:19], v[144:147], v[28:31]
    ds_read_b128 v[168:171], v1 offset:19456
    v_mfma_f32_16x16x32_bf16 v[44:47], v[16:19], v[152:155], v[28:31]
    ds_read_b128 v[172:175], v1 offset:20480
    v_mfma_f32_16x16x32_bf16 v[32:35], v[20:23], v[132:135], v[32:35]
    ds_read_b128 v[176:179], v1 offset:21504
    v_mfma_f32_16x16x32_bf16 v[36:39], v[20:23], v[140:143], v[36:39]
    ds_read_b128 v[180:183], v1 offset:22528
    v_mfma_f32_16x16x32_bf16 v[40:43], v[20:23], v[148:151], v[40:43]
    ds_read_b128 v[184:187], v1 offset:23552
    v_mfma_f32_16x16x32_bf16 v[44:47], v[20:23], v[156:159], v[44:47]
    ds_read_b128 v[188:191], v1 offset:24576
    v_mfma_f32_16x16x32_bf16 v[32:35], v[24:27], v[124:127], v[32:35]
    ds_read_b128 v[52:55], v1 offset:25600
    s_waitcnt vmcnt(1)
    buffer_store_dword v10, v7, s[8:11], s56 offen offset:384 sc1
    s_load_dwordx4 s[40:43], s[60:61], 0x100 glc
    s_load_dwordx4 s[44:47], s[60:61], 0x300 glc
    s_load_dwordx4 s[48:51], s[60:61], 0x500 glc
    s_load_dwordx4 s[52:55], s[60:61], 0x700 glc
    ds_read_b128 v[128:131], v1 offset:26624
    ds_read_b128 v[132:135], v1 offset:27648
    ds_read_b128 v[136:139], v1 offset:28672
    ds_read_b128 v[140:143], v1 offset:29696
    ds_read_b128 v[144:147], v1 offset:30720
    ds_read_b128 v[148:151], v1 offset:31744
    ds_read_b128 v[152:155], v1 offset:32768
    ds_read_b128 v[156:159], v1 offset:33792
    ds_read_b128 v[124:127], v1 offset:34816
    ds_read_b128 v[16:19], v1 offset:35840
    ds_read_b128 v[20:23], v1 offset:36864
    ds_read_b128 v[24:27], v1 offset:37888
    ds_read_b128 v[48:51], v1 offset:38912
    s_waitcnt lgkmcnt(0)
    s_and_b64 s[40:41], s[40:41], s[42:43]
    s_and_b64 s[44:45], s[44:45], s[46:47]
    s_and_b64 s[48:49], s[48:49], s[50:51]
    s_and_b64 s[52:53], s[52:53], s[54:55]
    s_and_b64 s[40:41], s[40:41], s[44:45]
    s_and_b64 s[48:49], s[48:49], s[52:53]
    s_and_b64 s[40:41], s[40:41], s[48:49]
    s_and_b32 s40, s40, s41
    s_cbranch_scc0 L_g1_p2_slow
L_g1_p2_ok:
    buffer_load_dwordx4 v[192:195], v1, s[8:11], s94 offen offset:0 sc1
    buffer_load_dwordx4 v[196:199], v1, s[8:11], s94 offen offset:1024 sc1
    buffer_load_dwordx4 v[200:203], v1, s[8:11], s94 offen offset:2048 sc1
    buffer_load_dwordx4 v[204:207], v1, s[8:11], s94 offen offset:3072 sc1
    buffer_load_dwordx4 v[208:211], v1, s[8:11], s95 offen offset:0 sc1
    buffer_load_dwordx4 v[212:215], v1, s[8:11], s95 offen offset:1024 sc1
    buffer_load_dwordx4 v[216:219], v1, s[8:11], s95 offen offset:2048 sc1
    buffer_load_dwordx4 v[220:223], v1, s[8:11], s95 offen offset:3072 sc1
    buffer_load_dwordx4 v[224:227], v1, s[8:11], s96 offen offset:0 sc1
    buffer_load_dwordx4 v[228:231], v1, s[8:11], s96 offen offset:1024 sc1
    buffer_load_dwordx4 v[232:235], v1, s[8:11], s96 offen offset:2048 sc1
    buffer_load_dwordx4 v[236:239], v1, s[8:11], s96 offen offset:3072 sc1
    buffer_load_dwordx4 v[240:243], v1, s[8:11], s97 offen offset:0 sc1
    s_waitcnt vmcnt(12)
    v_mfma_f32_16x16x32_bf16 v[32:35], v[192:195], v[56:59], v[32:35]
    ds_read_b128 v[28:31], v1 offset:39936
    v_mfma_f32_16x16x32_bf16 v[36:39], v[192:195], v[60:63], v[36:39]
    v_mfma_f32_16x16x32_bf16 v[40:43], v[192:195], v[64:67], v[40:43]
    ds_read_b128 v[56:59], v1 offset:40960
    v_mfma_f32_16x16x32_bf16 v[44:47], v[192:195], v[68:71], v[44:47]
    buffer_load_dwordx4 v[244:247], v1, s[8:11], s97 offen offset:1024 sc1
    s_waitcnt vmcnt(12)
    v_mfma_f32_16x16x32_bf16 v[32:35], v[196:199], v[72:75], v[32:35]
    ds_read_b128 v[60:63], v1 offset:41984
    v_mfma_f32_16x16x32_bf16 v[36:39], v[196:199], v[76:79], v[36:39]
    v_mfma_f32_16x16x32_bf16 v[40:43], v[196:199], v[80:83], v[40:43]
    ds_read_b128 v[64:67], v1 offset:43008
    v_mfma_f32_16x16x32_bf16 v[44:47], v[196:199], v[84:87], v[44:47]
    buffer_load_dwordx4 v[248:251], v1, s[8:11], s97 offen offset:2048 sc1
    s_waitcnt vmcnt(12)
    v_mfma_f32_16x16x32_bf16 v[32:35], v[200:203], v[88:91], v[32:35]
    ds_read_b128 v[68:71], v1 offset:44032
    v_mfma_f32_16x16x32_bf16 v[36:39], v[200:203], v[92:95], v[36:39]
    v_mfma_f32_16x16x32_bf16 v[40:43], v[200:203], v[96:99], v[40:43]
    ds_read_b128 v[72:75], v1 offset:45056
    v_mfma_f32_16x16x32_bf16 v[44:47], v[200:203], v[100:103], v[44:47]
    buffer_load_dwordx4 v[252:255], v1, s[8:11], s97 offen offset:3072 sc1
    s_waitcnt vmcnt(12)
    v_mfma_f32_16x16x32_bf16 v[32:35], v[204:207], v[104:107], v[32:35]
    ds_read_b128 v[76:79], v1 offset:46080
    v_mfma_f32_16x16x32_bf16 v[36:39], v[204:207], v[108:111], v[36:39]
    v_mfma_f32_16x16x32_bf16 v[40:43], v[204:207], v[112:115], v[40:43]
    ds_read_b128 v[80:83], v1 offset:47104
    v_mfma_f32_16x16x32_bf16 v[44:47], v[204:207], v[116:119], v[44:47]
    s_waitcnt vmcnt(11)
    v_mfma_f32_16x16x32_bf16 v[32:35], v[208:211], v[120:123], v[32:35]
    ds_read_b128 v[84:87], v1 offset:48128
    v_mfma_f32_16x16x32_bf16 v[36:39], v[208:211], v[160:163], v[36:39]
    v_mfma_f32_16x16x32_bf16 v[40:43], v[208:211], v[164:167], v[40:43]
    ds_read_b128 v[88:91], v1 offset:49152
    v_mfma_f32_16x16x32_bf16 v[44:47], v[208:211], v[168:171], v[44:47]
    s_waitcnt vmcnt(10)
    v_mfma_f32_16x16x32_bf16 v[32:35], v[212:215], v[172:175], v[32:35]
    ds_read_b128 v[92:95], v1 offset:50176
    v_mfma_f32_16x16x32_bf16 v[36:39], v[212:215], v[176:179], v[36:39]
    v_mfma_f32_16x16x32_bf16 v[40:43], v[212:215], v[180:183], v[40:43]
    ds_read_b128 v[96:99], v1 offset:51200
    v_mfma_f32_16x16x32_bf16 v[44:47], v[212:215], v[184:187], v[44:47]
    s_waitcnt vmcnt(9)
    v_mfma_f32_16x16x32_bf16 v[32:35], v[216:219], v[188:191], v[32:35]
    ds_read_b128 v[100:103], v1 offset:52224
    v_mfma_f32_16x16x32_bf16 v[36:39], v[216:219], v[52:55], v[36:39]
    v_mfma_f32_16x16x32_bf16 v[40:43], v[216:219], v[128:131], v[40:43]
    v_mfma_f32_16x16x32_bf16 v[44:47], v[216:219], v[132:135], v[44:47]
    ds_read_b128 v[104:107], v1 offset:53248
    s_waitcnt vmcnt(8)
    v_mfma_f32_16x16x32_bf16 v[32:35], v[220:223], v[136:139], v[32:35]
    v_mfma_f32_16x16x32_bf16 v[36:39], v[220:223], v[140:143], v[36:39]
    ds_read_b128 v[108:111], v1 offset:54272
    v_mfma_f32_16x16x32_bf16 v[40:43], v[220:223], v[144:147], v[40:43]
    v_mfma_f32_16x16x32_bf16 v[44:47], v[220:223], v[148:151], v[44:47]
    ds_read_b128 v[112:115], v1 offset:55296
    s_waitcnt vmcnt(7)
    v_mfma_f32_16x16x32_bf16 v[32:35], v[224:227], v[152:155], v[32:35]
    v_mfma_f32_16x16x32_bf16 v[36:39], v[224:227], v[156:159], v[36:39]
    ds_read_b128 v[116:119], v1 offset:56320
    v_mfma_f32_16x16x32_bf16 v[40:43], v[224:227], v[124:127], v[40:43]
    v_mfma_f32_16x16x32_bf16 v[44:47], v[224:227], v[16:19], v[44:47]
    ds_read_b128 v[120:123], v1 offset:57344
    s_waitcnt vmcnt(6)
    s_waitcnt lgkmcnt(14)
    v_mfma_f32_16x16x32_bf16 v[32:35], v[228:231], v[20:23], v[32:35]
    v_mfma_f32_16x16x32_bf16 v[36:39], v[228:231], v[24:27], v[36:39]
    ds_read_b128 v[160:163], v1 offset:58368
    v_mfma_f32_16x16x32_bf16 v[40:43], v[228:231], v[48:51], v[40:43]
    v_mfma_f32_16x16x32_bf16 v[44:47], v[228:231], v[28:31], v[44:47]
    ds_read_b128 v[164:167], v1 offset:59392
    s_waitcnt vmcnt(5)
    s_waitcnt lgkmcnt(14)
    v_mfma_f32_16x16x32_bf16 v[32:35], v[232:235], v[56:59], v[32:35]
    v_mfma_f32_16x16x32_bf16 v[36:39], v[232:235], v[60:63], v[36:39]
    ds_read_b128 v[168:171], v1 offset:60416
    v_mfma_f32_16x16x32_bf16 v[40:43], v[232:235], v[64:67], v[40:43]
    v_mfma_f32_16x16x32_bf16 v[44:47], v[232:235], v[68:71], v[44:47]
    ds_read_b128 v[172:175], v1 offset:61440
    s_waitcnt vmcnt(4)
    s_waitcnt lgkmcnt(13)
    v_mfma_f32_16x16x32_bf16 v[32:35], v[236:239], v[72:75], v[32:35]
    v_mfma_f32_16x16x32_bf16 v[36:39], v[236:239], v[76:79], v[36:39]
    ds_read_b128 v[176:179], v1 offset:62464
    v_mfma_f32_16x16x32_bf16 v[40:43], v[236:239], v[80:83], v[40:43]
    v_mfma_f32_16x16x32_bf16 v[44:47], v[236:239], v[84:87], v[44:47]
    ds_read_b128 v[180:183], v1 offset:63488
    s_waitcnt vmcnt(3)
    s_waitcnt lgkmcnt(11)
    v_mfma_f32_16x16x32_bf16 v[32:35], v[240:243], v[88:91], v[32:35]
    v_mfma_f32_16x16x32_bf16 v[36:39], v[240:243], v[92:95], v[36:39]
    ds_read_b128 v[184:187], v1 offset:64512
    v_mfma_f32_16x16x32_bf16 v[40:43], v[240:243], v[96:99], v[40:43]
    v_mfma_f32_16x16x32_bf16 v[44:47], v[240:243], v[100:103], v[44:47]
    s_waitcnt vmcnt(2)
    s_waitcnt lgkmcnt(8)
    v_mfma_f32_16x16x32_bf16 v[32:35], v[244:247], v[104:107], v[32:35]
    v_mfma_f32_16x16x32_bf16 v[36:39], v[244:247], v[108:111], v[36:39]
    v_mfma_f32_16x16x32_bf16 v[40:43], v[244:247], v[112:115], v[40:43]
    v_mfma_f32_16x16x32_bf16 v[44:47], v[244:247], v[116:119], v[44:47]
    s_waitcnt vmcnt(1)
    s_waitcnt lgkmcnt(4)
    v_mfma_f32_16x16x32_bf16 v[32:35], v[248:251], v[120:123], v[32:35]
    v_mfma_f32_16x16x32_bf16 v[36:39], v[248:251], v[160:163], v[36:39]
    v_mfma_f32_16x16x32_bf16 v[40:43], v[248:251], v[164:167], v[40:43]
    v_mfma_f32_16x16x32_bf16 v[44:47], v[248:251], v[168:171], v[44:47]
    s_waitcnt vmcnt(0)
    s_waitcnt lgkmcnt(0)
    v_mfma_f32_16x16x32_bf16 v[32:35], v[252:255], v[172:175], v[32:35]
    v_mfma_f32_16x16x32_bf16 v[36:39], v[252:255], v[176:179], v[36:39]
    v_mfma_f32_16x16x32_bf16 v[40:43], v[252:255], v[180:183], v[40:43]
    v_mfma_f32_16x16x32_bf16 v[44:47], v[252:255], v[184:187], v[44:47]
    s_nop 4
    ds_write_b128 v8, v[32:35] offset:0
    ds_write_b128 v8, v[36:39] offset:1024
    ds_write_b128 v8, v[40:43] offset:2048
    ds_write_b128 v8, v[44:47] offset:3072
    s_waitcnt lgkmcnt(0)
    s_barrier
    s_endpgm
L_end:
    s_endpgm
.section .rodata,"a"
.p2align 6
.amdhsa_kernel sequential_preLN__spectral_fnet__swiglu_ffn__prompt_kernel
  .amdhsa_next_free_vgpr 256
  .amdhsa_next_free_sgpr 102
  .amdhsa_accum_offset 256
  .amdhsa_group_segment_fixed_size 0
  .amdhsa_kernarg_size 96
  .amdhsa_user_sgpr_count 2
  .amdhsa_user_sgpr_kernarg_segment_ptr 1
  .amdhsa_system_sgpr_workgroup_id_x 1
  .amdhsa_float_denorm_mode_32 3
.end_amdhsa_kernel
```
